```python
import torch

def _softmax(x, axis=-1):
    return torch.softmax(x, dim=axis)
def _gelu(x):
    return torch.nn.functional.gelu(x, approximate="tanh")
def _silu(x):
    return torch.nn.functional.silu(x)
def _sigmoid(x):
    return torch.sigmoid(x)
def _layernorm(x, axis=-1, eps=1e-5):
    m = x.mean(dim=axis, keepdim=True)
    v = x.var(dim=axis, keepdim=True, unbiased=False)
    return (x - m) / torch.sqrt(v + eps)
def _scatter_add(tgt, idx, src, axis=0):
    return tgt.clone().index_add_(axis, idx, src)
def _segment_sum(src, seg, n):
    out = torch.zeros((n,) + src.shape[1:], dtype=src.dtype)
    return out.index_add_(0, seg, src)
def _pad(x, pw):
    flat = tuple(v for pair in reversed(pw) for v in pair)
    return torch.nn.functional.pad(x, flat)

kernel_name = 'gated_mix__linear_attn_block__mha_block__prompt'

def setup_inputs():

    _w = (lambda a: (lambda t: t.to(torch.bfloat16) if t.is_floating_point() else t)(torch.as_tensor(a)))
    def _A_setup():
        B, S, D = 1, 2048, 640
        return {
            "x": _w((lambda *s: torch.randn(*s, dtype=torch.bfloat16) * 0.05)(B, S, D)),
            "wqkv": _w((lambda *s: torch.randn(*s, dtype=torch.bfloat16) * 0.8)(D, 3 * D)),
            "wo": _w((lambda *s: torch.randn(*s, dtype=torch.bfloat16) * 0.2)(D, D)),
        }
    _A_in = _A_setup()

    def _B_setup():
        B, S, D, H = 1, 2048, 640, 32
        return {
            "x": _w((lambda *s: torch.randn(*s, dtype=torch.bfloat16) * 0.05)(B, S, D)),
            "wqkv": _w((lambda *s: torch.randn(*s, dtype=torch.bfloat16) * 0.8)(D, 3 * D)),
            "wo": _w((lambda *s: torch.randn(*s, dtype=torch.bfloat16) * 0.05)(D, D)),
        }
    _B_in = _B_setup()

    return {
        "A_x": _A_in["x"],
        "A_wqkv": _A_in["wqkv"],
        "A_wo": _A_in["wo"],
        "B_x": _B_in["x"],
        "B_wqkv": _B_in["wqkv"],
        "B_wo": _B_in["wo"],
        "gate_w": _w((lambda *s: torch.randn(*s, dtype=torch.bfloat16) * 0.05)(640) * 16.0),
    }

def reference(A_x, A_wqkv, A_wo, B_x, B_wqkv, B_wo, gate_w):
    def _A_ref(x, wqkv, wo):
        B, S, D = x.shape
        H = 32; Dh = D // H
        qkv = (lambda x, *d: x.permute(*d))((x @ wqkv).reshape(B, S, 3, H, Dh), 2, 0, 3, 1, 4)
        q, k, v = qkv[0], qkv[1], qkv[2]
        phi = lambda t: torch.where(t > 0, t + 1, torch.exp(t)) + 1e-6
        pq, pk = phi(q), phi(k)
        kv = torch.einsum("bhsd,bhse->bhde", pk, v)
        z = torch.einsum("bhsd->bhd", pk)
        num = torch.einsum("bhqd,bhde->bhqe", pq, kv)
        den = torch.einsum("bhqd,bhd->bhq", pq, z)[..., None] + 1e-6
        o = num / den
        return (lambda x, *d: x.permute(*d))(o, 0, 2, 1, 3).reshape(B, S, D) @ wo

    def _B_ref(x, wqkv, wo):
        B, S, D = x.shape
        H = 32
        Dh = D // H
        qkv = (lambda x, *d: x.permute(*d))((x @ wqkv).reshape(B, S, 3, H, Dh), 2, 0, 3, 1, 4)
        q, k, v = qkv[0], qkv[1], qkv[2]
        scores = torch.einsum("bhqd,bhkd->bhqk", q, k) * (Dh ** -0.5)
        p = _softmax(scores, axis=-1)
        o = torch.einsum("bhqk,bhkd->bhqd", p, v)
        return (lambda x, *d: x.permute(*d))(o, 0, 2, 1, 3).reshape(B, S, D) @ wo

    x = A_x
    g = _sigmoid((x * gate_w).sum(-1, keepdims=True))
    a = _A_ref(x, A_wqkv, A_wo)
    b = _B_ref(x, B_wqkv, B_wo)
    return g * a + (1 - g) * b
```

```asm
; @launch kernel=k1_kernel grid=(240,1,1) block=(1024,1,1) lds=163840
; @launch kernel=k2_kernel grid=(256,1,1) block=(512,1,1) lds=131072
; @launch kernel=k3_kernel grid=(256,1,1) block=(256,1,1) lds=81920
.amdgcn_target "amdgcn-amd-amdhsa--gfx950"
.text
.p2align 8
.globl k1_kernel
.type k1_kernel,@function
k1_kernel:
    s_cmp_ge_u32 s2, 240
    s_cbranch_scc1 k1_kernel_done
    s_load_dwordx4 s[4:7], s[0:1], 0
    s_load_dwordx2 s[8:9], s[0:1], 32
    s_load_dwordx2 s[10:11], s[0:1], 48
    s_load_dwordx2 s[12:13], s[0:1], 72
    s_and_b32 s3, s2, 7
    s_lshr_b32 s19, s2, 3
    s_mul_i32 s3, s3, 30
    s_add_u32 s3, s3, s19
    s_cmp_ge_u32 s3, 120
    s_cselect_b32 s14, 8, 0
    s_cselect_b32 s19, 120, 0
    s_sub_u32 s3, s3, s19
    s_lshr_b32 s15, s3, 3
    s_and_b32 s19, s3, 7
    s_add_u32 s14, s14, s19
    v_lshrrev_b32 v2, 6, v0
    v_and_b32 v1, 63, v0
    s_nop 0
    v_readfirstlane_b32 s18, v2
    s_waitcnt lgkmcnt(0)
    s_mov_b32 s20, s4
    s_and_b32 s21, s5, 0xffff
    s_mov_b32 s22, 2621440
    s_mov_b32 s23, 0x00020000
    s_mov_b32 s24, s6
    s_and_b32 s25, s7, 0xffff
    s_mov_b32 s26, 2457600
    s_mov_b32 s27, 0x00020000
    s_mov_b32 s36, s8
    s_and_b32 s37, s9, 0xffff
    s_mov_b32 s38, 2457600
    s_mov_b32 s39, 0x00020000
    s_mov_b32 s28, s12
    s_and_b32 s29, s13, 0xffff
    s_mov_b32 s30, 22659072
    s_mov_b32 s31, 0x00020000
    s_mov_b32 s32, s10
    s_and_b32 s33, s11, 0xffff
    s_mov_b32 s34, 1280
    s_mov_b32 s35, 0x00020000
    s_lshr_b32 s16, s18, 2
    s_and_b32 s17, s18, 3
    s_cmp_ge_u32 s15, 5
    s_cselect_b32 s40, 1, 0
    s_cmp_ge_u32 s15, 10
    s_cselect_b32 s40, 2, s40
    s_mul_i32 s41, s40, 5
    s_sub_u32 s41, s15, s41
    s_lshl_b32 s42, s14, 7
    s_lshl_b32 s43, s15, 4
    s_add_u32 s42, s42, s43
    s_lshl_b32 s43, s18, 1
    s_add_u32 s42, s42, s43
    s_mul_i32 s43, s42, 1280
    v_lshlrev_b32 v5, 2, v1
    s_cmp_ge_u32 s18, 8
    s_cbranch_scc0 k1_kernel_compute
    s_sub_u32 s44, s18, 8
    v_subrev_u32 v7, 512, v0
    v_mov_b32 v118, v0
    v_subrev_u32 v119, 512, v118
    v_lshlrev_b32 v117, 7, v119
    s_mul_i32 s50, s2, 10240
    s_mul_i32 s51, s2, 11264
    v_mov_b32 v116, 0x7ffffff0
    v_cmp_gt_u32 vcc, 80, v119
    s_nop 1
    v_cndmask_b32 v118, v116, v117, vcc
    buffer_load_dword v126, v118, s[24:27], s50 offen
    buffer_load_dword v126, v118, s[36:39], s50 offen
    v_cmp_gt_u32 vcc, 88, v119
    s_nop 1
    v_cndmask_b32 v118, v116, v117, vcc
    buffer_load_dword v127, v118, s[20:23], s51 offen
    v_lshrrev_b32 v6, 4, v1
    v_and_b32 v7, 15, v1
    s_lshr_b32 s45, s44, 2
    s_lshl_b32 s45, s45, 5
    s_and_b32 s46, s44, 1
    s_lshl_b32 s46, s46, 4
    s_add_u32 s45, s45, s46
    s_bfe_u32 s46, s44, 0x10001
    s_lshl_b32 s46, s46, 2
    s_add_u32 s45, s45, s46
    s_lshl_b32 s46, s15, 8
    v_add_u32 v8, s45, v6
    v_mul_u32_u24 v8, 3840, v8
    v_add_u32 v8, s46, v8
    v_lshlrev_b32 v9, 1, v6
    v_xor_b32 v9, v9, v7
    v_lshl_add_u32 v120, v9, 4, v8
    v_xor_b32 v9, 8, v9
    v_lshl_add_u32 v121, v9, 4, v8
    v_lshrrev_b32 v6, 3, v1
    v_and_b32 v7, 7, v1
    s_lshl_b32 s45, s14, 7
    s_lshl_b32 s46, s44, 4
    s_add_u32 s45, s45, s46
    v_add_u32 v8, s45, v6
    v_mul_u32_u24 v8, 1280, v8
    v_lshl_add_u32 v122, v7, 4, v8
    v_lshrrev_b32 v9, 1, v6
    v_xor_b32 v9, v9, v7
    s_lshl_b32 s46, s44, 11
    s_add_u32 s46, s46, 131072
    v_lshlrev_b32 v8, 7, v6
    v_add_u32 v8, s46, v8
    v_lshl_add_u32 v123, v9, 4, v8
    v_xor_b32 v9, 4, v9
    v_lshl_add_u32 v124, v9, 4, v8
    s_lshl_b32 s46, s44, 11
    s_mov_b32 s60, 0
    s_mov_b32 s61, 10240
    v_mov_b32 v125, v1
    buffer_load_dwordx4 v[0:3], v122, s[20:23], s60 offen offset:0
    buffer_load_dwordx4 v[4:7], v122, s[20:23], s61 offen offset:0
    s_mov_b32 s47, 0
    s_add_u32 m0, s46, 0
    s_nop 0
    buffer_load_dwordx4 v120, s[24:27], s47 offen lds
    s_mov_b32 s47, 30720
    s_add_u32 m0, s46, 1024
    s_nop 0
    buffer_load_dwordx4 v121, s[24:27], s47 offen lds
    s_mov_b32 s47, 0
    s_add_u32 m0, s46, 16384
    s_nop 0
    buffer_load_dwordx4 v120, s[36:39], s47 offen lds
    s_mov_b32 s47, 30720
    s_add_u32 m0, s46, 17408
    s_nop 0
    buffer_load_dwordx4 v121, s[36:39], s47 offen lds
    buffer_load_dwordx4 v[8:11], v122, s[20:23], s60 offen offset:128
    buffer_load_dwordx4 v[12:15], v122, s[20:23], s61 offen offset:128
    s_mov_b32 s47, 245760
    s_add_u32 m0, s46, 32768
    s_nop 0
    buffer_load_dwordx4 v120, s[24:27], s47 offen lds
    s_mov_b32 s47, 276480
    s_add_u32 m0, s46, 33792
    s_nop 0
    buffer_load_dwordx4 v121, s[24:27], s47 offen lds
    s_mov_b32 s47, 245760
    s_add_u32 m0, s46, 49152
    s_nop 0
    buffer_load_dwordx4 v120, s[36:39], s47 offen lds
    s_mov_b32 s47, 276480
    s_add_u32 m0, s46, 50176
    s_nop 0
    buffer_load_dwordx4 v121, s[36:39], s47 offen lds
    buffer_load_dwordx4 v[16:19], v122, s[20:23], s60 offen offset:256
    buffer_load_dwordx4 v[20:23], v122, s[20:23], s61 offen offset:256
    s_mov_b32 s47, 491520
    s_add_u32 m0, s46, 65536
    s_nop 0
    buffer_load_dwordx4 v120, s[24:27], s47 offen lds
    s_mov_b32 s47, 522240
    s_add_u32 m0, s46, 66560
    s_nop 0
    buffer_load_dwordx4 v121, s[24:27], s47 offen lds
    s_mov_b32 s47, 491520
    s_add_u32 m0, s46, 81920
    s_nop 0
    buffer_load_dwordx4 v120, s[36:39], s47 offen lds
    s_mov_b32 s47, 522240
    s_add_u32 m0, s46, 82944
    s_nop 0
    buffer_load_dwordx4 v121, s[36:39], s47 offen lds
    s_waitcnt vmcnt(12)
    ds_write_b128 v123, v[0:3] offset:0
    ds_write_b128 v124, v[4:7] offset:1024
    s_waitcnt lgkmcnt(0)
    s_barrier
    buffer_load_dwordx4 v[24:27], v122, s[20:23], s60 offen offset:384
    buffer_load_dwordx4 v[28:31], v122, s[20:23], s61 offen offset:384
    s_mov_b32 s47, 737280
    s_add_u32 m0, s46, 98304
    s_nop 0
    buffer_load_dwordx4 v120, s[24:27], s47 offen lds
    s_mov_b32 s47, 768000
    s_add_u32 m0, s46, 99328
    s_nop 0
    buffer_load_dwordx4 v121, s[24:27], s47 offen lds
    s_mov_b32 s47, 737280
    s_add_u32 m0, s46, 114688
    s_nop 0
    buffer_load_dwordx4 v120, s[36:39], s47 offen lds
    s_mov_b32 s47, 768000
    s_add_u32 m0, s46, 115712
    s_nop 0
    buffer_load_dwordx4 v121, s[36:39], s47 offen lds
    buffer_load_dwordx4 v[32:35], v122, s[20:23], s60 offen offset:512
    buffer_load_dwordx4 v[36:39], v122, s[20:23], s61 offen offset:512
    buffer_load_dwordx4 v[40:43], v122, s[20:23], s60 offen offset:640
    buffer_load_dwordx4 v[44:47], v122, s[20:23], s61 offen offset:640
    s_waitcnt vmcnt(16)
    ds_write_b128 v123, v[8:11] offset:16384
    ds_write_b128 v124, v[12:15] offset:17408
    s_waitcnt lgkmcnt(0)
    s_barrier
    s_mov_b32 s47, 983040
    s_add_u32 m0, s46, 0
    s_nop 0
    buffer_load_dwordx4 v120, s[24:27], s47 offen lds
    s_mov_b32 s47, 1013760
    s_add_u32 m0, s46, 1024
    s_nop 0
    buffer_load_dwordx4 v121, s[24:27], s47 offen lds
    s_mov_b32 s47, 983040
    s_add_u32 m0, s46, 16384
    s_nop 0
    buffer_load_dwordx4 v120, s[36:39], s47 offen lds
    s_mov_b32 s47, 1013760
    s_add_u32 m0, s46, 17408
    s_nop 0
    buffer_load_dwordx4 v121, s[36:39], s47 offen lds
    buffer_load_dwordx4 v[48:51], v122, s[20:23], s60 offen offset:768
    buffer_load_dwordx4 v[52:55], v122, s[20:23], s61 offen offset:768
    buffer_load_dwordx4 v[56:59], v122, s[20:23], s60 offen offset:896
    buffer_load_dwordx4 v[60:63], v122, s[20:23], s61 offen offset:896
    s_waitcnt vmcnt(18)
    ds_write_b128 v123, v[16:19] offset:0
    ds_write_b128 v124, v[20:23] offset:1024
    s_waitcnt lgkmcnt(0)
    s_barrier
    s_mov_b32 s47, 1228800
    s_add_u32 m0, s46, 32768
    s_nop 0
    buffer_load_dwordx4 v120, s[24:27], s47 offen lds
    s_mov_b32 s47, 1259520
    s_add_u32 m0, s46, 33792
    s_nop 0
    buffer_load_dwordx4 v121, s[24:27], s47 offen lds
    s_mov_b32 s47, 1228800
    s_add_u32 m0, s46, 49152
    s_nop 0
    buffer_load_dwordx4 v120, s[36:39], s47 offen lds
    s_mov_b32 s47, 1259520
    s_add_u32 m0, s46, 50176
    s_nop 0
    buffer_load_dwordx4 v121, s[36:39], s47 offen lds
    buffer_load_dwordx4 v[64:67], v122, s[20:23], s60 offen offset:1024
    buffer_load_dwordx4 v[68:71], v122, s[20:23], s61 offen offset:1024
    buffer_load_dwordx4 v[72:75], v122, s[20:23], s60 offen offset:1152
    buffer_load_dwordx4 v[76:79], v122, s[20:23], s61 offen offset:1152
    s_waitcnt vmcnt(20)
    ds_write_b128 v123, v[24:27] offset:16384
    ds_write_b128 v124, v[28:31] offset:17408
    s_waitcnt lgkmcnt(0)
    s_barrier
    s_mov_b32 s47, 1474560
    s_add_u32 m0, s46, 65536
    s_nop 0
    buffer_load_dwordx4 v120, s[24:27], s47 offen lds
    s_mov_b32 s47, 1505280
    s_add_u32 m0, s46, 66560
    s_nop 0
    buffer_load_dwordx4 v121, s[24:27], s47 offen lds
    s_mov_b32 s47, 1474560
    s_add_u32 m0, s46, 81920
    s_nop 0
    buffer_load_dwordx4 v120, s[36:39], s47 offen lds
    s_mov_b32 s47, 1505280
    s_add_u32 m0, s46, 82944
    s_nop 0
    buffer_load_dwordx4 v121, s[36:39], s47 offen lds
    s_waitcnt vmcnt(16)
    ds_write_b128 v123, v[32:35] offset:0
    ds_write_b128 v124, v[36:39] offset:1024
    s_waitcnt lgkmcnt(0)
    s_barrier
    s_mov_b32 s47, 1720320
    s_add_u32 m0, s46, 98304
    s_nop 0
    buffer_load_dwordx4 v120, s[24:27], s47 offen lds
    s_mov_b32 s47, 1751040
    s_add_u32 m0, s46, 99328
    s_nop 0
    buffer_load_dwordx4 v121, s[24:27], s47 offen lds
    s_mov_b32 s47, 1720320
    s_add_u32 m0, s46, 114688
    s_nop 0
    buffer_load_dwordx4 v120, s[36:39], s47 offen lds
    s_mov_b32 s47, 1751040
    s_add_u32 m0, s46, 115712
    s_nop 0
    buffer_load_dwordx4 v121, s[36:39], s47 offen lds
    s_waitcnt vmcnt(12)
    ds_write_b128 v123, v[40:43] offset:16384
    ds_write_b128 v124, v[44:47] offset:17408
    s_waitcnt lgkmcnt(0)
    s_barrier
    s_mov_b32 s47, 1966080
    s_add_u32 m0, s46, 0
    s_nop 0
    buffer_load_dwordx4 v120, s[24:27], s47 offen lds
    s_mov_b32 s47, 1996800
    s_add_u32 m0, s46, 1024
    s_nop 0
    buffer_load_dwordx4 v121, s[24:27], s47 offen lds
    s_mov_b32 s47, 1966080
    s_add_u32 m0, s46, 16384
    s_nop 0
    buffer_load_dwordx4 v120, s[36:39], s47 offen lds
    s_mov_b32 s47, 1996800
    s_add_u32 m0, s46, 17408
    s_nop 0
    buffer_load_dwordx4 v121, s[36:39], s47 offen lds
    s_waitcnt vmcnt(8)
    ds_write_b128 v123, v[48:51] offset:0
    ds_write_b128 v124, v[52:55] offset:1024
    s_waitcnt lgkmcnt(0)
    s_barrier
    s_mov_b32 s47, 2211840
    s_add_u32 m0, s46, 32768
    s_nop 0
    buffer_load_dwordx4 v120, s[24:27], s47 offen lds
    s_mov_b32 s47, 2242560
    s_add_u32 m0, s46, 33792
    s_nop 0
    buffer_load_dwordx4 v121, s[24:27], s47 offen lds
    s_mov_b32 s47, 2211840
    s_add_u32 m0, s46, 49152
    s_nop 0
    buffer_load_dwordx4 v120, s[36:39], s47 offen lds
    s_mov_b32 s47, 2242560
    s_add_u32 m0, s46, 50176
    s_nop 0
    buffer_load_dwordx4 v121, s[36:39], s47 offen lds
    s_waitcnt vmcnt(8)
    ds_write_b128 v123, v[56:59] offset:16384
    ds_write_b128 v124, v[60:63] offset:17408
    s_waitcnt lgkmcnt(0)
    s_barrier
    s_waitcnt vmcnt(4)
    ds_write_b128 v123, v[64:67] offset:0
    ds_write_b128 v124, v[68:71] offset:1024
    s_waitcnt lgkmcnt(0)
    s_barrier
    s_waitcnt vmcnt(0)
    ds_write_b128 v123, v[72:75] offset:16384
    ds_write_b128 v124, v[76:79] offset:17408
    s_waitcnt lgkmcnt(0)
    s_barrier
    s_load_dwordx2 s[48:49], s[0:1], 16
    s_load_dwordx2 s[50:51], s[0:1], 40
    s_lshl_b32 s52, s2, 3
    s_add_u32 s52, s52, s44
    s_mul_i32 s53, s52, 5243
    s_lshr_b32 s53, s53, 20
    s_mul_i32 s54, s53, 200
    s_sub_u32 s54, s52, s54
    s_mul_i32 s55, s54, 52429
    s_lshr_b32 s55, s55, 18
    s_mul_i32 s56, s55, 5
    s_sub_u32 s56, s54, s56
    s_waitcnt lgkmcnt(0)
    s_mov_b32 s64, s48
    s_and_b32 s65, s49, 0xffff
    s_mov_b32 s66, 819200
    s_mov_b32 s67, 0x00020000
    s_mov_b32 s60, s50
    s_and_b32 s61, s51, 0xffff
    s_mov_b32 s62, 819200
    s_mov_b32 s63, 0x00020000
    v_and_b32 v2, 15, v125
    v_lshrrev_b32 v3, 4, v125
    s_lshl_b32 s57, s55, 2
    v_add_u32 v3, s57, v3
    v_mul_u32_u24 v6, 205, v3
    v_lshrrev_b32 v6, 10, v6
    v_mul_u32_u24 v7, 5, v6
    v_sub_u32 v7, v3, v7
    v_mul_u32_u24 v6, 20, v6
    v_and_b32 v8, 1, v7
    v_lshlrev_b32 v8, 2, v8
    v_cmp_eq_u32 vcc, 4, v7
    v_mov_b32 v9, 16
    s_nop 0
    v_cndmask_b32 v8, v8, v9, vcc
    v_add_u32 v6, v6, v8
    v_mov_b32 v9, 8
    v_cndmask_b32 v9, v9, 0, vcc
    s_mul_i32 s57, s53, 160
    s_lshl_b32 s58, s56, 5
    s_add_u32 s57, s57, s58
    v_lshlrev_b32 v10, 1, v2
    v_add_u32 v10, s57, v10
    v_mov_b32 v11, 0x7ffffff0
    s_cmp_ge_u32 s52, 1600
    s_cbranch_scc1 k1now_1
    v_mov_b32 v12, v6
    v_mul_u32_u24 v12, 1280, v12
    v_add_u32 v12, v12, v10
    v_cmp_gt_u32 vcc, 2, v7
    v_cmp_eq_u32 s[58:59], 4, v7
    s_or_b64 vcc, vcc, s[58:59]
    s_nop 1
    v_cndmask_b32 v13, v11, v12, vcc
    v_cndmask_b32 v14, v12, v11, vcc
    buffer_load_ushort v40, v13, s[60:63], 0 offen offset:0
    buffer_load_ushort v48, v14, s[64:67], 0 offen offset:0
    buffer_load_ushort v41, v13, s[60:63], 0 offen offset:1280
    buffer_load_ushort v49, v14, s[64:67], 0 offen offset:1280
    buffer_load_ushort v42, v13, s[60:63], 0 offen offset:2560
    buffer_load_ushort v50, v14, s[64:67], 0 offen offset:2560
    buffer_load_ushort v43, v13, s[60:63], 0 offen offset:3840
    buffer_load_ushort v51, v14, s[64:67], 0 offen offset:3840
    v_add_u32 v12, v6, v9
    v_mul_u32_u24 v12, 1280, v12
    v_add_u32 v12, v12, v10
    v_cmp_gt_u32 vcc, 2, v7
    s_nop 1
    v_cndmask_b32 v13, v11, v12, vcc
    v_cndmask_b32 v14, v12, v11, vcc
    buffer_load_ushort v44, v13, s[60:63], 0 offen offset:0
    buffer_load_ushort v52, v14, s[64:67], 0 offen offset:0
    buffer_load_ushort v45, v13, s[60:63], 0 offen offset:1280
    buffer_load_ushort v53, v14, s[64:67], 0 offen offset:1280
    buffer_load_ushort v46, v13, s[60:63], 0 offen offset:2560
    buffer_load_ushort v54, v14, s[64:67], 0 offen offset:2560
    buffer_load_ushort v47, v13, s[60:63], 0 offen offset:3840
    buffer_load_ushort v55, v14, s[64:67], 0 offen offset:3840
    s_waitcnt vmcnt(0)
    v_or_b32 v40, v40, v48
    v_or_b32 v41, v41, v49
    v_or_b32 v42, v42, v50
    v_or_b32 v43, v43, v51
    v_or_b32 v44, v44, v52
    v_or_b32 v45, v45, v53
    v_or_b32 v46, v46, v54
    v_or_b32 v47, v47, v55
    v_lshl_or_b32 v40, v41, 16, v40
    v_lshl_or_b32 v41, v43, 16, v42
    v_lshl_or_b32 v42, v45, 16, v44
    v_lshl_or_b32 v43, v47, 16, v46
    v_lshlrev_b32 v5, 4, v125
    s_lshl_b32 s53, s52, 10
    s_add_u32 s53, s53, 21020672
    buffer_store_dwordx4 v[40:43], v5, s[28:31], s53 offen
k1now_1:
    s_cmp_ge_u32 s15, 8
    s_cbranch_scc1 k1_kernel_fin
    s_lshl_b32 s42, s14, 7
    s_lshl_b32 s43, s15, 4
    s_add_u32 s42, s42, s43
    s_lshl_b32 s43, s44, 1
    s_add_u32 s42, s42, s43
    s_mul_i32 s43, s42, 1280
    v_lshlrev_b32 v5, 2, v125
    buffer_load_dword v100, v5, s[32:35], 0 offen offset:0
    buffer_load_dword v101, v5, s[32:35], 0 offen offset:256
    buffer_load_dword v102, v5, s[32:35], 0 offen offset:512
    buffer_load_dword v103, v5, s[32:35], 0 offen offset:768
    buffer_load_dword v104, v5, s[32:35], 0 offen offset:1024
    buffer_load_dword v105, v5, s[20:23], s43 offen offset:0
    buffer_load_dword v106, v5, s[20:23], s43 offen offset:256
    buffer_load_dword v107, v5, s[20:23], s43 offen offset:512
    buffer_load_dword v108, v5, s[20:23], s43 offen offset:768
    buffer_load_dword v109, v5, s[20:23], s43 offen offset:1024
    buffer_load_dword v110, v5, s[20:23], s43 offen offset:1280
    buffer_load_dword v111, v5, s[20:23], s43 offen offset:1536
    buffer_load_dword v112, v5, s[20:23], s43 offen offset:1792
    buffer_load_dword v113, v5, s[20:23], s43 offen offset:2048
    buffer_load_dword v114, v5, s[20:23], s43 offen offset:2304
    s_waitcnt vmcnt(0)
    s_mov_b32 s55, 0xffff0000
    v_lshlrev_b32 v30, 16, v100
    v_lshlrev_b32 v31, 16, v105
    v_mul_f32 v20, v30, v31
    v_and_b32 v30, s55, v100
    v_and_b32 v31, s55, v105
    v_fmac_f32 v20, v30, v31
    v_lshlrev_b32 v30, 16, v101
    v_lshlrev_b32 v31, 16, v106
    v_fmac_f32 v20, v30, v31
    v_and_b32 v30, s55, v101
    v_and_b32 v31, s55, v106
    v_fmac_f32 v20, v30, v31
    v_lshlrev_b32 v30, 16, v102
    v_lshlrev_b32 v31, 16, v107
    v_fmac_f32 v20, v30, v31
    v_and_b32 v30, s55, v102
    v_and_b32 v31, s55, v107
    v_fmac_f32 v20, v30, v31
    v_lshlrev_b32 v30, 16, v103
    v_lshlrev_b32 v31, 16, v108
    v_fmac_f32 v20, v30, v31
    v_and_b32 v30, s55, v103
    v_and_b32 v31, s55, v108
    v_fmac_f32 v20, v30, v31
    v_lshlrev_b32 v30, 16, v104
    v_lshlrev_b32 v31, 16, v109
    v_fmac_f32 v20, v30, v31
    v_and_b32 v30, s55, v104
    v_and_b32 v31, s55, v109
    v_fmac_f32 v20, v30, v31
    v_lshlrev_b32 v30, 16, v100
    v_lshlrev_b32 v31, 16, v110
    v_mul_f32 v21, v30, v31
    v_and_b32 v30, s55, v100
    v_and_b32 v31, s55, v110
    v_fmac_f32 v21, v30, v31
    v_lshlrev_b32 v30, 16, v101
    v_lshlrev_b32 v31, 16, v111
    v_fmac_f32 v21, v30, v31
    v_and_b32 v30, s55, v101
    v_and_b32 v31, s55, v111
    v_fmac_f32 v21, v30, v31
    v_lshlrev_b32 v30, 16, v102
    v_lshlrev_b32 v31, 16, v112
    v_fmac_f32 v21, v30, v31
    v_and_b32 v30, s55, v102
    v_and_b32 v31, s55, v112
    v_fmac_f32 v21, v30, v31
    v_lshlrev_b32 v30, 16, v103
    v_lshlrev_b32 v31, 16, v113
    v_fmac_f32 v21, v30, v31
    v_and_b32 v30, s55, v103
    v_and_b32 v31, s55, v113
    v_fmac_f32 v21, v30, v31
    v_lshlrev_b32 v30, 16, v104
    v_lshlrev_b32 v31, 16, v114
    v_fmac_f32 v21, v30, v31
    v_and_b32 v30, s55, v104
    v_and_b32 v31, s55, v114
    v_fmac_f32 v21, v30, v31
    s_nop 1
    v_add_f32_dpp v20, v20, v20 row_ror:8 row_mask:0xf bank_mask:0xf
    v_add_f32_dpp v21, v21, v21 row_ror:8 row_mask:0xf bank_mask:0xf
    s_nop 1
    v_add_f32_dpp v20, v20, v20 row_ror:4 row_mask:0xf bank_mask:0xf
    v_add_f32_dpp v21, v21, v21 row_ror:4 row_mask:0xf bank_mask:0xf
    s_nop 1
    v_add_f32_dpp v20, v20, v20 row_ror:2 row_mask:0xf bank_mask:0xf
    v_add_f32_dpp v21, v21, v21 row_ror:2 row_mask:0xf bank_mask:0xf
    s_nop 1
    v_add_f32_dpp v20, v20, v20 row_ror:1 row_mask:0xf bank_mask:0xf
    v_add_f32_dpp v21, v21, v21 row_ror:1 row_mask:0xf bank_mask:0xf
    s_nop 0
    v_readlane_b32 s46, v20, 0
    v_readlane_b32 s47, v20, 16
    v_readlane_b32 s48, v20, 32
    v_readlane_b32 s49, v20, 48
    v_readlane_b32 s50, v21, 0
    v_readlane_b32 s51, v21, 16
    v_readlane_b32 s52, v21, 32
    v_readlane_b32 s53, v21, 48
    s_nop 1
    v_mov_b32 v20, s46
    v_add_f32 v20, s47, v20
    v_add_f32 v20, s48, v20
    v_add_f32 v20, s49, v20
    v_mov_b32 v21, s50
    v_add_f32 v21, s51, v21
    v_add_f32 v21, s52, v21
    v_add_f32 v21, s53, v21
    v_cmp_eq_u32 vcc, 1, v125
    s_nop 1
    v_cndmask_b32 v20, v20, v21, vcc
    s_mov_b32 s52, 0x3fb8aa3b
    v_mul_f32 v20, s52, v20
    v_sub_f32 v20, 0, v20
    v_exp_f32 v20, v20
    s_nop 0
    v_add_f32 v20, 1.0, v20
    v_rcp_f32 v20, v20
    v_add_u32 v22, s42, v125
    v_lshlrev_b32 v22, 2, v22
    s_mov_b32 s55, 15769600
    s_mov_b64 exec, 3
    buffer_store_dword v20, v22, s[28:31], s55 offen
    s_mov_b64 exec, -1
    s_branch k1_kernel_fin
k1_kernel_compute:
    v_and_b32 v2, 15, v1
    v_lshrrev_b32 v3, 4, v1
    v_lshrrev_b32 v4, 1, v2
    v_xor_b32 v4, v4, v3
    s_lshl_b32 s44, s16, 13
    s_add_u32 s44, s44, 131072
    v_lshlrev_b32 v6, 7, v2
    v_add_u32 v6, s44, v6
    v_lshl_add_u32 v14, v4, 4, v6
    v_xor_b32 v4, 4, v4
    v_lshl_add_u32 v15, v4, 4, v6
    v_lshrrev_b32 v4, 2, v1
    v_and_b32 v6, 7, v4
    v_lshlrev_b32 v7, 8, v4
    v_and_b32 v8, 3, v1
    v_lshl_add_u32 v7, v8, 3, v7
    s_lshr_b32 s44, s17, 1
    s_lshl_b32 s44, s44, 14
    v_add_u32 v7, s44, v7
    s_and_b32 s44, s17, 1
    s_lshl_b32 s44, s44, 2
    s_add_u32 s45, s44, 0
    v_xor_b32 v8, s45, v6
    v_lshl_add_u32 v16, v8, 5, v7
    s_add_u32 s45, s44, 1
    v_xor_b32 v8, s45, v6
    v_lshl_add_u32 v17, v8, 5, v7
    s_add_u32 s45, s44, 2
    v_xor_b32 v8, s45, v6
    v_lshl_add_u32 v18, v8, 5, v7
    s_add_u32 s45, s44, 3
    v_xor_b32 v8, s45, v6
    v_lshl_add_u32 v19, v8, 5, v7
    s_lshr_b32 s49, s17, 1
    s_cmp_eq_u32 s40, 0
    s_cbranch_scc1 k1_kernel_WX
    s_cmp_eq_u32 s40, 1
    s_cselect_b32 s50, s49, 0
    s_cmp_eq_u32 s50, 1
    s_cbranch_scc1 k1_kernel_WX
    v_mov_b32 v8, v14
    v_mov_b32 v9, v15
    v_mov_b32 v10, v16
    v_mov_b32 v11, v17
    v_mov_b32 v12, v18
    v_mov_b32 v13, v19
    v_mov_b32 v64, 0
    v_mov_b32 v65, 0
    v_mov_b32 v66, 0
    v_mov_b32 v67, 0
    v_mov_b32 v68, 0
    v_mov_b32 v69, 0
    v_mov_b32 v70, 0
    v_mov_b32 v71, 0
    v_mov_b32 v72, 0
    v_mov_b32 v73, 0
    v_mov_b32 v74, 0
    v_mov_b32 v75, 0
    v_mov_b32 v76, 0
    v_mov_b32 v77, 0
    v_mov_b32 v78, 0
    v_mov_b32 v79, 0
    v_mov_b32 v80, 0
    v_mov_b32 v81, 0
    v_mov_b32 v82, 0
    v_mov_b32 v83, 0
    v_mov_b32 v84, 0
    v_mov_b32 v85, 0
    v_mov_b32 v86, 0
    v_mov_b32 v87, 0
    v_mov_b32 v88, 0
    v_mov_b32 v89, 0
    v_mov_b32 v90, 0
    v_mov_b32 v91, 0
    v_mov_b32 v92, 0
    v_mov_b32 v93, 0
    v_mov_b32 v94, 0
    v_mov_b32 v95, 0
    v_mov_b32 v96, 0
    v_mov_b32 v97, 0
    v_mov_b32 v98, 0
    v_mov_b32 v99, 0
    v_mov_b32 v100, 0
    v_mov_b32 v101, 0
    v_mov_b32 v102, 0
    v_mov_b32 v103, 0
    v_mov_b32 v104, 0
    v_mov_b32 v105, 0
    v_mov_b32 v106, 0
    v_mov_b32 v107, 0
    v_mov_b32 v108, 0
    v_mov_b32 v109, 0
    v_mov_b32 v110, 0
    v_mov_b32 v111, 0
    v_mov_b32 v112, 0
    v_mov_b32 v113, 0
    v_mov_b32 v114, 0
    v_mov_b32 v115, 0
    v_mov_b32 v116, 0
    v_mov_b32 v117, 0
    v_mov_b32 v118, 0
    v_mov_b32 v119, 0
    v_mov_b32 v120, 0
    v_mov_b32 v121, 0
    v_mov_b32 v122, 0
    v_mov_b32 v123, 0
    v_mov_b32 v124, 0
    v_mov_b32 v125, 0
    v_mov_b32 v126, 0
    v_mov_b32 v127, 0
    s_mov_b32 s70, 0
    s_waitcnt lgkmcnt(0)
    s_barrier
    ds_read_b64_tr_b16 v[32:33], v10 offset:0
    ds_read_b64_tr_b16 v[34:35], v10 offset:4096
    ds_read_b64_tr_b16 v[36:37], v11 offset:0
    ds_read_b64_tr_b16 v[38:39], v11 offset:4096
    ds_read_b64_tr_b16 v[40:41], v12 offset:0
    ds_read_b64_tr_b16 v[42:43], v12 offset:4096
    ds_read_b64_tr_b16 v[44:45], v13 offset:0
    ds_read_b64_tr_b16 v[46:47], v13 offset:4096
    ds_read_b128 v[16:19], v8 offset:0
    ds_read_b128 v[20:23], v8 offset:2048
    ds_read_b128 v[24:27], v8 offset:4096
    ds_read_b128 v[28:31], v8 offset:6144
k1loop_2:
    ds_read_b64_tr_b16 v[48:49], v10 offset:8192
    ds_read_b64_tr_b16 v[50:51], v10 offset:12288
    ds_read_b64_tr_b16 v[52:53], v11 offset:8192
    ds_read_b64_tr_b16 v[54:55], v11 offset:12288
    ds_read_b64_tr_b16 v[56:57], v12 offset:8192
    ds_read_b64_tr_b16 v[58:59], v12 offset:12288
    ds_read_b64_tr_b16 v[60:61], v13 offset:8192
    ds_read_b64_tr_b16 v[62:63], v13 offset:12288
    s_waitcnt lgkmcnt(11)
    v_mfma_f32_16x16x32_bf16 v[64:67], v[16:19], v[32:35], v[64:67]
    v_mfma_f32_16x16x32_bf16 v[68:71], v[16:19], v[36:39], v[68:71]
    v_mfma_f32_16x16x32_bf16 v[72:75], v[16:19], v[40:43], v[72:75]
    v_mfma_f32_16x16x32_bf16 v[76:79], v[16:19], v[44:47], v[76:79]
    ds_read_b128 v[16:19], v9 offset:0
    s_waitcnt lgkmcnt(11)
    v_mfma_f32_16x16x32_bf16 v[80:83], v[20:23], v[32:35], v[80:83]
    v_mfma_f32_16x16x32_bf16 v[84:87], v[20:23], v[36:39], v[84:87]
    v_mfma_f32_16x16x32_bf16 v[88:91], v[20:23], v[40:43], v[88:91]
    v_mfma_f32_16x16x32_bf16 v[92:95], v[20:23], v[44:47], v[92:95]
    ds_read_b128 v[20:23], v9 offset:2048
    s_waitcnt lgkmcnt(11)
    v_mfma_f32_16x16x32_bf16 v[96:99], v[24:27], v[32:35], v[96:99]
    v_mfma_f32_16x16x32_bf16 v[100:103], v[24:27], v[36:39], v[100:103]
    v_mfma_f32_16x16x32_bf16 v[104:107], v[24:27], v[40:43], v[104:107]
    v_mfma_f32_16x16x32_bf16 v[108:111], v[24:27], v[44:47], v[108:111]
    ds_read_b128 v[24:27], v9 offset:4096
    s_waitcnt lgkmcnt(11)
    v_mfma_f32_16x16x32_bf16 v[112:115], v[28:31], v[32:35], v[112:115]
    v_mfma_f32_16x16x32_bf16 v[116:119], v[28:31], v[36:39], v[116:119]
    v_mfma_f32_16x16x32_bf16 v[120:123], v[28:31], v[40:43], v[120:123]
    v_mfma_f32_16x16x32_bf16 v[124:127], v[28:31], v[44:47], v[124:127]
    ds_read_b128 v[28:31], v9 offset:6144
    s_waitcnt lgkmcnt(0)
    s_barrier
    v_xor_b32 v8, 16384, v8
    v_xor_b32 v9, 16384, v9
    v_add_u32 v10, 32768, v10
    v_add_u32 v11, 32768, v11
    v_add_u32 v12, 32768, v12
    v_add_u32 v13, 32768, v13
    v_and_b32 v10, 0x1ffff, v10
    v_and_b32 v11, 0x1ffff, v11
    v_and_b32 v12, 0x1ffff, v12
    v_and_b32 v13, 0x1ffff, v13
    ds_read_b64_tr_b16 v[32:33], v10 offset:0
    ds_read_b64_tr_b16 v[34:35], v10 offset:4096
    ds_read_b64_tr_b16 v[36:37], v11 offset:0
    ds_read_b64_tr_b16 v[38:39], v11 offset:4096
    ds_read_b64_tr_b16 v[40:41], v12 offset:0
    ds_read_b64_tr_b16 v[42:43], v12 offset:4096
    ds_read_b64_tr_b16 v[44:45], v13 offset:0
    ds_read_b64_tr_b16 v[46:47], v13 offset:4096
    s_waitcnt lgkmcnt(11)
    v_mfma_f32_16x16x32_bf16 v[64:67], v[16:19], v[48:51], v[64:67]
    v_mfma_f32_16x16x32_bf16 v[68:71], v[16:19], v[52:55], v[68:71]
    v_mfma_f32_16x16x32_bf16 v[72:75], v[16:19], v[56:59], v[72:75]
    v_mfma_f32_16x16x32_bf16 v[76:79], v[16:19], v[60:63], v[76:79]
    ds_read_b128 v[16:19], v8 offset:0
    s_waitcnt lgkmcnt(11)
    v_mfma_f32_16x16x32_bf16 v[80:83], v[20:23], v[48:51], v[80:83]
    v_mfma_f32_16x16x32_bf16 v[84:87], v[20:23], v[52:55], v[84:87]
    v_mfma_f32_16x16x32_bf16 v[88:91], v[20:23], v[56:59], v[88:91]
    v_mfma_f32_16x16x32_bf16 v[92:95], v[20:23], v[60:63], v[92:95]
    ds_read_b128 v[20:23], v8 offset:2048
    s_waitcnt lgkmcnt(11)
    v_mfma_f32_16x16x32_bf16 v[96:99], v[24:27], v[48:51], v[96:99]
    v_mfma_f32_16x16x32_bf16 v[100:103], v[24:27], v[52:55], v[100:103]
    v_mfma_f32_16x16x32_bf16 v[104:107], v[24:27], v[56:59], v[104:107]
    v_mfma_f32_16x16x32_bf16 v[108:111], v[24:27], v[60:63], v[108:111]
    ds_read_b128 v[24:27], v8 offset:4096
    s_waitcnt lgkmcnt(11)
    v_mfma_f32_16x16x32_bf16 v[112:115], v[28:31], v[48:51], v[112:115]
    v_mfma_f32_16x16x32_bf16 v[116:119], v[28:31], v[52:55], v[116:119]
    v_mfma_f32_16x16x32_bf16 v[120:123], v[28:31], v[56:59], v[120:123]
    v_mfma_f32_16x16x32_bf16 v[124:127], v[28:31], v[60:63], v[124:127]
    ds_read_b128 v[28:31], v8 offset:6144
    s_add_u32 s70, s70, 1
    s_cmp_lt_u32 s70, 9
    s_cbranch_scc1 k1loop_2
    ds_read_b64_tr_b16 v[48:49], v10 offset:8192
    ds_read_b64_tr_b16 v[50:51], v10 offset:12288
    ds_read_b64_tr_b16 v[52:53], v11 offset:8192
    ds_read_b64_tr_b16 v[54:55], v11 offset:12288
    ds_read_b64_tr_b16 v[56:57], v12 offset:8192
    ds_read_b64_tr_b16 v[58:59], v12 offset:12288
    ds_read_b64_tr_b16 v[60:61], v13 offset:8192
    ds_read_b64_tr_b16 v[62:63], v13 offset:12288
    s_waitcnt lgkmcnt(11)
    v_mfma_f32_16x16x32_bf16 v[64:67], v[16:19], v[32:35], v[64:67]
    v_mfma_f32_16x16x32_bf16 v[68:71], v[16:19], v[36:39], v[68:71]
    v_mfma_f32_16x16x32_bf16 v[72:75], v[16:19], v[40:43], v[72:75]
    v_mfma_f32_16x16x32_bf16 v[76:79], v[16:19], v[44:47], v[76:79]
    ds_read_b128 v[16:19], v9 offset:0
    s_waitcnt lgkmcnt(11)
    v_mfma_f32_16x16x32_bf16 v[80:83], v[20:23], v[32:35], v[80:83]
    v_mfma_f32_16x16x32_bf16 v[84:87], v[20:23], v[36:39], v[84:87]
    v_mfma_f32_16x16x32_bf16 v[88:91], v[20:23], v[40:43], v[88:91]
    v_mfma_f32_16x16x32_bf16 v[92:95], v[20:23], v[44:47], v[92:95]
    ds_read_b128 v[20:23], v9 offset:2048
    s_waitcnt lgkmcnt(11)
    v_mfma_f32_16x16x32_bf16 v[96:99], v[24:27], v[32:35], v[96:99]
    v_mfma_f32_16x16x32_bf16 v[100:103], v[24:27], v[36:39], v[100:103]
    v_mfma_f32_16x16x32_bf16 v[104:107], v[24:27], v[40:43], v[104:107]
    v_mfma_f32_16x16x32_bf16 v[108:111], v[24:27], v[44:47], v[108:111]
    ds_read_b128 v[24:27], v9 offset:4096
    s_waitcnt lgkmcnt(11)
    v_mfma_f32_16x16x32_bf16 v[112:115], v[28:31], v[32:35], v[112:115]
    v_mfma_f32_16x16x32_bf16 v[116:119], v[28:31], v[36:39], v[116:119]
    v_mfma_f32_16x16x32_bf16 v[120:123], v[28:31], v[40:43], v[120:123]
    v_mfma_f32_16x16x32_bf16 v[124:127], v[28:31], v[44:47], v[124:127]
    ds_read_b128 v[28:31], v9 offset:6144
    s_waitcnt lgkmcnt(0)
    s_waitcnt lgkmcnt(3)
    v_mfma_f32_16x16x32_bf16 v[64:67], v[16:19], v[48:51], v[64:67]
    v_mfma_f32_16x16x32_bf16 v[68:71], v[16:19], v[52:55], v[68:71]
    v_mfma_f32_16x16x32_bf16 v[72:75], v[16:19], v[56:59], v[72:75]
    v_mfma_f32_16x16x32_bf16 v[76:79], v[16:19], v[60:63], v[76:79]
    s_waitcnt lgkmcnt(2)
    v_mfma_f32_16x16x32_bf16 v[80:83], v[20:23], v[48:51], v[80:83]
    v_mfma_f32_16x16x32_bf16 v[84:87], v[20:23], v[52:55], v[84:87]
    v_mfma_f32_16x16x32_bf16 v[88:91], v[20:23], v[56:59], v[88:91]
    v_mfma_f32_16x16x32_bf16 v[92:95], v[20:23], v[60:63], v[92:95]
    s_waitcnt lgkmcnt(1)
    v_mfma_f32_16x16x32_bf16 v[96:99], v[24:27], v[48:51], v[96:99]
    v_mfma_f32_16x16x32_bf16 v[100:103], v[24:27], v[52:55], v[100:103]
    v_mfma_f32_16x16x32_bf16 v[104:107], v[24:27], v[56:59], v[104:107]
    v_mfma_f32_16x16x32_bf16 v[108:111], v[24:27], v[60:63], v[108:111]
    s_waitcnt lgkmcnt(0)
    v_mfma_f32_16x16x32_bf16 v[112:115], v[28:31], v[48:51], v[112:115]
    v_mfma_f32_16x16x32_bf16 v[116:119], v[28:31], v[52:55], v[116:119]
    v_mfma_f32_16x16x32_bf16 v[120:123], v[28:31], v[56:59], v[120:123]
    v_mfma_f32_16x16x32_bf16 v[124:127], v[28:31], v[60:63], v[124:127]
    s_nop 9
    s_mov_b32 s52, 0x3fb8aa3b
    s_mov_b32 s53, 0x3fb8aa3b
    s_mov_b32 s66, 0x358637bd
    s_mov_b32 s67, 0x358637bd
    s_mov_b32 s54, 0x3ea52b5c
    s_mov_b32 s68, 0x3ea52b5c
    s_mov_b32 s69, 0x3ea52b5c
    v_and_b32 v2, 15, v1
    v_lshrrev_b32 v3, 4, v1
    s_mov_b32 s59, 10485760
    s_cmp_eq_u32 s40, 2
    s_cselect_b32 s59, 13107200, s59
    s_lshl_b32 s60, s40, 1
    s_add_u32 s60, s60, s49
    s_cmp_eq_u32 s60, 5
    s_cselect_b32 s59, 7864320, s59
    s_cmp_eq_u32 s40, 1
    s_cbranch_scc0 k1nophi_3
    v_pk_mul_f32 v[32:33], v[64:65], s[52:53]
    v_pk_mul_f32 v[34:35], v[66:67], s[52:53]
    v_pk_mul_f32 v[36:37], v[68:69], s[52:53]
    v_pk_mul_f32 v[38:39], v[70:71], s[52:53]
    v_pk_mul_f32 v[40:41], v[72:73], s[52:53]
    v_pk_mul_f32 v[42:43], v[74:75], s[52:53]
    v_pk_mul_f32 v[44:45], v[76:77], s[52:53]
    v_pk_mul_f32 v[46:47], v[78:79], s[52:53]
    v_exp_f32_e64 v32, v32 clamp
    v_exp_f32_e64 v33, v33 clamp
    v_exp_f32_e64 v34, v34 clamp
    v_exp_f32_e64 v35, v35 clamp
    v_exp_f32_e64 v36, v36 clamp
    v_exp_f32_e64 v37, v37 clamp
    v_exp_f32_e64 v38, v38 clamp
    v_exp_f32_e64 v39, v39 clamp
    v_exp_f32_e64 v40, v40 clamp
    v_exp_f32_e64 v41, v41 clamp
    v_exp_f32_e64 v42, v42 clamp
    v_exp_f32_e64 v43, v43 clamp
    v_exp_f32_e64 v44, v44 clamp
    v_exp_f32_e64 v45, v45 clamp
    v_exp_f32_e64 v46, v46 clamp
    v_exp_f32_e64 v47, v47 clamp
    v_max_f32 v64, 0, v64
    v_max_f32 v65, 0, v65
    v_max_f32 v66, 0, v66
    v_max_f32 v67, 0, v67
    v_max_f32 v68, 0, v68
    v_max_f32 v69, 0, v69
    v_max_f32 v70, 0, v70
    v_max_f32 v71, 0, v71
    v_max_f32 v72, 0, v72
    v_max_f32 v73, 0, v73
    v_max_f32 v74, 0, v74
    v_max_f32 v75, 0, v75
    v_max_f32 v76, 0, v76
    v_max_f32 v77, 0, v77
    v_max_f32 v78, 0, v78
    v_max_f32 v79, 0, v79
    v_pk_add_f32 v[32:33], v[32:33], s[66:67]
    v_pk_add_f32 v[34:35], v[34:35], s[66:67]
    v_pk_add_f32 v[36:37], v[36:37], s[66:67]
    v_pk_add_f32 v[38:39], v[38:39], s[66:67]
    v_pk_add_f32 v[40:41], v[40:41], s[66:67]
    v_pk_add_f32 v[42:43], v[42:43], s[66:67]
    v_pk_add_f32 v[44:45], v[44:45], s[66:67]
    v_pk_add_f32 v[46:47], v[46:47], s[66:67]
    v_pk_add_f32 v[64:65], v[64:65], v[32:33]
    v_pk_add_f32 v[66:67], v[66:67], v[34:35]
    v_pk_add_f32 v[68:69], v[68:69], v[36:37]
    v_pk_add_f32 v[70:71], v[70:71], v[38:39]
    v_pk_add_f32 v[72:73], v[72:73], v[40:41]
    v_pk_add_f32 v[74:75], v[74:75], v[42:43]
    v_pk_add_f32 v[76:77], v[76:77], v[44:45]
    v_pk_add_f32 v[78:79], v[78:79], v[46:47]
    v_pk_mul_f32 v[32:33], v[80:81], s[52:53]
    v_pk_mul_f32 v[34:35], v[82:83], s[52:53]
    v_pk_mul_f32 v[36:37], v[84:85], s[52:53]
    v_pk_mul_f32 v[38:39], v[86:87], s[52:53]
    v_pk_mul_f32 v[40:41], v[88:89], s[52:53]
    v_pk_mul_f32 v[42:43], v[90:91], s[52:53]
    v_pk_mul_f32 v[44:45], v[92:93], s[52:53]
    v_pk_mul_f32 v[46:47], v[94:95], s[52:53]
    v_exp_f32_e64 v32, v32 clamp
    v_exp_f32_e64 v33, v33 clamp
    v_exp_f32_e64 v34, v34 clamp
    v_exp_f32_e64 v35, v35 clamp
    v_exp_f32_e64 v36, v36 clamp
    v_exp_f32_e64 v37, v37 clamp
    v_exp_f32_e64 v38, v38 clamp
    v_exp_f32_e64 v39, v39 clamp
    v_exp_f32_e64 v40, v40 clamp
    v_exp_f32_e64 v41, v41 clamp
    v_exp_f32_e64 v42, v42 clamp
    v_exp_f32_e64 v43, v43 clamp
    v_exp_f32_e64 v44, v44 clamp
    v_exp_f32_e64 v45, v45 clamp
    v_exp_f32_e64 v46, v46 clamp
    v_exp_f32_e64 v47, v47 clamp
    v_max_f32 v80, 0, v80
    v_max_f32 v81, 0, v81
    v_max_f32 v82, 0, v82
    v_max_f32 v83, 0, v83
    v_max_f32 v84, 0, v84
    v_max_f32 v85, 0, v85
    v_max_f32 v86, 0, v86
    v_max_f32 v87, 0, v87
    v_max_f32 v88, 0, v88
    v_max_f32 v89, 0, v89
    v_max_f32 v90, 0, v90
    v_max_f32 v91, 0, v91
    v_max_f32 v92, 0, v92
    v_max_f32 v93, 0, v93
    v_max_f32 v94, 0, v94
    v_max_f32 v95, 0, v95
    v_pk_add_f32 v[32:33], v[32:33], s[66:67]
    v_pk_add_f32 v[34:35], v[34:35], s[66:67]
    v_pk_add_f32 v[36:37], v[36:37], s[66:67]
    v_pk_add_f32 v[38:39], v[38:39], s[66:67]
    v_pk_add_f32 v[40:41], v[40:41], s[66:67]
    v_pk_add_f32 v[42:43], v[42:43], s[66:67]
    v_pk_add_f32 v[44:45], v[44:45], s[66:67]
    v_pk_add_f32 v[46:47], v[46:47], s[66:67]
    v_pk_add_f32 v[80:81], v[80:81], v[32:33]
    v_pk_add_f32 v[82:83], v[82:83], v[34:35]
    v_pk_add_f32 v[84:85], v[84:85], v[36:37]
    v_pk_add_f32 v[86:87], v[86:87], v[38:39]
    v_pk_add_f32 v[88:89], v[88:89], v[40:41]
    v_pk_add_f32 v[90:91], v[90:91], v[42:43]
    v_pk_add_f32 v[92:93], v[92:93], v[44:45]
    v_pk_add_f32 v[94:95], v[94:95], v[46:47]
    v_pk_mul_f32 v[32:33], v[96:97], s[52:53]
    v_pk_mul_f32 v[34:35], v[98:99], s[52:53]
    v_pk_mul_f32 v[36:37], v[100:101], s[52:53]
    v_pk_mul_f32 v[38:39], v[102:103], s[52:53]
    v_pk_mul_f32 v[40:41], v[104:105], s[52:53]
    v_pk_mul_f32 v[42:43], v[106:107], s[52:53]
    v_pk_mul_f32 v[44:45], v[108:109], s[52:53]
    v_pk_mul_f32 v[46:47], v[110:111], s[52:53]
    v_exp_f32_e64 v32, v32 clamp
    v_exp_f32_e64 v33, v33 clamp
    v_exp_f32_e64 v34, v34 clamp
    v_exp_f32_e64 v35, v35 clamp
    v_exp_f32_e64 v36, v36 clamp
    v_exp_f32_e64 v37, v37 clamp
    v_exp_f32_e64 v38, v38 clamp
    v_exp_f32_e64 v39, v39 clamp
    v_exp_f32_e64 v40, v40 clamp
    v_exp_f32_e64 v41, v41 clamp
    v_exp_f32_e64 v42, v42 clamp
    v_exp_f32_e64 v43, v43 clamp
    v_exp_f32_e64 v44, v44 clamp
    v_exp_f32_e64 v45, v45 clamp
    v_exp_f32_e64 v46, v46 clamp
    v_exp_f32_e64 v47, v47 clamp
    v_max_f32 v96, 0, v96
    v_max_f32 v97, 0, v97
    v_max_f32 v98, 0, v98
    v_max_f32 v99, 0, v99
    v_max_f32 v100, 0, v100
    v_max_f32 v101, 0, v101
    v_max_f32 v102, 0, v102
    v_max_f32 v103, 0, v103
    v_max_f32 v104, 0, v104
    v_max_f32 v105, 0, v105
    v_max_f32 v106, 0, v106
    v_max_f32 v107, 0, v107
    v_max_f32 v108, 0, v108
    v_max_f32 v109, 0, v109
    v_max_f32 v110, 0, v110
    v_max_f32 v111, 0, v111
    v_pk_add_f32 v[32:33], v[32:33], s[66:67]
    v_pk_add_f32 v[34:35], v[34:35], s[66:67]
    v_pk_add_f32 v[36:37], v[36:37], s[66:67]
    v_pk_add_f32 v[38:39], v[38:39], s[66:67]
    v_pk_add_f32 v[40:41], v[40:41], s[66:67]
    v_pk_add_f32 v[42:43], v[42:43], s[66:67]
    v_pk_add_f32 v[44:45], v[44:45], s[66:67]
    v_pk_add_f32 v[46:47], v[46:47], s[66:67]
    v_pk_add_f32 v[96:97], v[96:97], v[32:33]
    v_pk_add_f32 v[98:99], v[98:99], v[34:35]
    v_pk_add_f32 v[100:101], v[100:101], v[36:37]
    v_pk_add_f32 v[102:103], v[102:103], v[38:39]
    v_pk_add_f32 v[104:105], v[104:105], v[40:41]
    v_pk_add_f32 v[106:107], v[106:107], v[42:43]
    v_pk_add_f32 v[108:109], v[108:109], v[44:45]
    v_pk_add_f32 v[110:111], v[110:111], v[46:47]
    v_pk_mul_f32 v[32:33], v[112:113], s[52:53]
    v_pk_mul_f32 v[34:35], v[114:115], s[52:53]
    v_pk_mul_f32 v[36:37], v[116:117], s[52:53]
    v_pk_mul_f32 v[38:39], v[118:119], s[52:53]
    v_pk_mul_f32 v[40:41], v[120:121], s[52:53]
    v_pk_mul_f32 v[42:43], v[122:123], s[52:53]
    v_pk_mul_f32 v[44:45], v[124:125], s[52:53]
    v_pk_mul_f32 v[46:47], v[126:127], s[52:53]
    v_exp_f32_e64 v32, v32 clamp
    v_exp_f32_e64 v33, v33 clamp
    v_exp_f32_e64 v34, v34 clamp
    v_exp_f32_e64 v35, v35 clamp
    v_exp_f32_e64 v36, v36 clamp
    v_exp_f32_e64 v37, v37 clamp
    v_exp_f32_e64 v38, v38 clamp
    v_exp_f32_e64 v39, v39 clamp
    v_exp_f32_e64 v40, v40 clamp
    v_exp_f32_e64 v41, v41 clamp
    v_exp_f32_e64 v42, v42 clamp
    v_exp_f32_e64 v43, v43 clamp
    v_exp_f32_e64 v44, v44 clamp
    v_exp_f32_e64 v45, v45 clamp
    v_exp_f32_e64 v46, v46 clamp
    v_exp_f32_e64 v47, v47 clamp
    v_max_f32 v112, 0, v112
    v_max_f32 v113, 0, v113
    v_max_f32 v114, 0, v114
    v_max_f32 v115, 0, v115
    v_max_f32 v116, 0, v116
    v_max_f32 v117, 0, v117
    v_max_f32 v118, 0, v118
    v_max_f32 v119, 0, v119
    v_max_f32 v120, 0, v120
    v_max_f32 v121, 0, v121
    v_max_f32 v122, 0, v122
    v_max_f32 v123, 0, v123
    v_max_f32 v124, 0, v124
    v_max_f32 v125, 0, v125
    v_max_f32 v126, 0, v126
    v_max_f32 v127, 0, v127
    v_pk_add_f32 v[32:33], v[32:33], s[66:67]
    v_pk_add_f32 v[34:35], v[34:35], s[66:67]
    v_pk_add_f32 v[36:37], v[36:37], s[66:67]
    v_pk_add_f32 v[38:39], v[38:39], s[66:67]
    v_pk_add_f32 v[40:41], v[40:41], s[66:67]
    v_pk_add_f32 v[42:43], v[42:43], s[66:67]
    v_pk_add_f32 v[44:45], v[44:45], s[66:67]
    v_pk_add_f32 v[46:47], v[46:47], s[66:67]
    v_pk_add_f32 v[112:113], v[112:113], v[32:33]
    v_pk_add_f32 v[114:115], v[114:115], v[34:35]
    v_pk_add_f32 v[116:117], v[116:117], v[36:37]
    v_pk_add_f32 v[118:119], v[118:119], v[38:39]
    v_pk_add_f32 v[120:121], v[120:121], v[40:41]
    v_pk_add_f32 v[122:123], v[122:123], v[42:43]
    v_pk_add_f32 v[124:125], v[124:125], v[44:45]
    v_pk_add_f32 v[126:127], v[126:127], v[46:47]
k1nophi_3:
    s_lshl_b32 s56, s41, 7
    s_and_b32 s57, s17, 1
    s_lshl_b32 s57, s57, 6
    s_add_u32 s56, s56, s57
    v_add_u32 v4, s56, v2
    s_lshl_b32 s57, s14, 2
    s_lshl_b32 s58, s16, 1
    s_add_u32 s57, s57, s58
    v_mul_u32_u24 v5, 320, v3
    v_add_u32 v6, 0, v4
    v_mul_u32_u24 v7, 3277, v6
    v_lshrrev_b32 v7, 16, v7
    v_mul_u32_u24 v8, 20, v7
    v_sub_u32 v8, v6, v8
    v_lshlrev_b32 v9, 6, v7
    v_add_u32 v9, s57, v9
    v_mul_u32_u24 v9, 1280, v9
    v_add_u32 v9, v9, v5
    v_lshl_add_u32 v9, v8, 4, v9
    v_cvt_pk_bf16_f32 v32, v64, v65
    v_cvt_pk_bf16_f32 v33, v66, v67
    v_cvt_pk_bf16_f32 v34, v80, v81
    v_cvt_pk_bf16_f32 v35, v82, v83
    buffer_store_dwordx4 v[32:35], v9, s[28:31], s59 offen offset:0
    v_cvt_pk_bf16_f32 v36, v96, v97
    v_cvt_pk_bf16_f32 v37, v98, v99
    v_cvt_pk_bf16_f32 v38, v112, v113
    v_cvt_pk_bf16_f32 v39, v114, v115
    buffer_store_dwordx4 v[36:39], v9, s[28:31], s59 offen offset:1280
    s_nop 0
    v_add_u32 v6, 16, v4
    v_mul_u32_u24 v7, 3277, v6
    v_lshrrev_b32 v7, 16, v7
    v_mul_u32_u24 v8, 20, v7
    v_sub_u32 v8, v6, v8
    v_lshlrev_b32 v9, 6, v7
    v_add_u32 v9, s57, v9
    v_mul_u32_u24 v9, 1280, v9
    v_add_u32 v9, v9, v5
    v_lshl_add_u32 v9, v8, 4, v9
    v_cvt_pk_bf16_f32 v40, v68, v69
    v_cvt_pk_bf16_f32 v41, v70, v71
    v_cvt_pk_bf16_f32 v42, v84, v85
    v_cvt_pk_bf16_f32 v43, v86, v87
    buffer_store_dwordx4 v[40:43], v9, s[28:31], s59 offen offset:0
    v_cvt_pk_bf16_f32 v44, v100, v101
    v_cvt_pk_bf16_f32 v45, v102, v103
    v_cvt_pk_bf16_f32 v46, v116, v117
    v_cvt_pk_bf16_f32 v47, v118, v119
    buffer_store_dwordx4 v[44:47], v9, s[28:31], s59 offen offset:1280
    s_nop 0
    v_add_u32 v6, 32, v4
    v_mul_u32_u24 v7, 3277, v6
    v_lshrrev_b32 v7, 16, v7
    v_mul_u32_u24 v8, 20, v7
    v_sub_u32 v8, v6, v8
    v_lshlrev_b32 v9, 6, v7
    v_add_u32 v9, s57, v9
    v_mul_u32_u24 v9, 1280, v9
    v_add_u32 v9, v9, v5
    v_lshl_add_u32 v9, v8, 4, v9
    v_cvt_pk_bf16_f32 v48, v72, v73
    v_cvt_pk_bf16_f32 v49, v74, v75
    v_cvt_pk_bf16_f32 v50, v88, v89
    v_cvt_pk_bf16_f32 v51, v90, v91
    buffer_store_dwordx4 v[48:51], v9, s[28:31], s59 offen offset:0
    v_cvt_pk_bf16_f32 v52, v104, v105
    v_cvt_pk_bf16_f32 v53, v106, v107
    v_cvt_pk_bf16_f32 v54, v120, v121
    v_cvt_pk_bf16_f32 v55, v122, v123
    buffer_store_dwordx4 v[52:55], v9, s[28:31], s59 offen offset:1280
    s_nop 0
    v_add_u32 v6, 48, v4
    v_mul_u32_u24 v7, 3277, v6
    v_lshrrev_b32 v7, 16, v7
    v_mul_u32_u24 v8, 20, v7
    v_sub_u32 v8, v6, v8
    v_lshlrev_b32 v9, 6, v7
    v_add_u32 v9, s57, v9
    v_mul_u32_u24 v9, 1280, v9
    v_add_u32 v9, v9, v5
    v_lshl_add_u32 v9, v8, 4, v9
    v_cvt_pk_bf16_f32 v56, v76, v77
    v_cvt_pk_bf16_f32 v57, v78, v79
    v_cvt_pk_bf16_f32 v58, v92, v93
    v_cvt_pk_bf16_f32 v59, v94, v95
    buffer_store_dwordx4 v[56:59], v9, s[28:31], s59 offen offset:0
    v_cvt_pk_bf16_f32 v60, v108, v109
    v_cvt_pk_bf16_f32 v61, v110, v111
    v_cvt_pk_bf16_f32 v62, v124, v125
    v_cvt_pk_bf16_f32 v63, v126, v127
    buffer_store_dwordx4 v[60:63], v9, s[28:31], s59 offen offset:1280
    s_nop 0
    s_branch k1_kernel_fin
k1_kernel_WX:
    v_mov_b32 v8, v14
    v_mov_b32 v9, v15
    v_mov_b32 v10, v16
    v_mov_b32 v11, v17
    v_mov_b32 v12, v18
    v_mov_b32 v13, v19
    v_mov_b32 v64, 0
    v_mov_b32 v65, 0
    v_mov_b32 v66, 0
    v_mov_b32 v67, 0
    v_mov_b32 v68, 0
    v_mov_b32 v69, 0
    v_mov_b32 v70, 0
    v_mov_b32 v71, 0
    v_mov_b32 v72, 0
    v_mov_b32 v73, 0
    v_mov_b32 v74, 0
    v_mov_b32 v75, 0
    v_mov_b32 v76, 0
    v_mov_b32 v77, 0
    v_mov_b32 v78, 0
    v_mov_b32 v79, 0
    v_mov_b32 v80, 0
    v_mov_b32 v81, 0
    v_mov_b32 v82, 0
    v_mov_b32 v83, 0
    v_mov_b32 v84, 0
    v_mov_b32 v85, 0
    v_mov_b32 v86, 0
    v_mov_b32 v87, 0
    v_mov_b32 v88, 0
    v_mov_b32 v89, 0
    v_mov_b32 v90, 0
    v_mov_b32 v91, 0
    v_mov_b32 v92, 0
    v_mov_b32 v93, 0
    v_mov_b32 v94, 0
    v_mov_b32 v95, 0
    v_mov_b32 v96, 0
    v_mov_b32 v97, 0
    v_mov_b32 v98, 0
    v_mov_b32 v99, 0
    v_mov_b32 v100, 0
    v_mov_b32 v101, 0
    v_mov_b32 v102, 0
    v_mov_b32 v103, 0
    v_mov_b32 v104, 0
    v_mov_b32 v105, 0
    v_mov_b32 v106, 0
    v_mov_b32 v107, 0
    v_mov_b32 v108, 0
    v_mov_b32 v109, 0
    v_mov_b32 v110, 0
    v_mov_b32 v111, 0
    v_mov_b32 v112, 0
    v_mov_b32 v113, 0
    v_mov_b32 v114, 0
    v_mov_b32 v115, 0
    v_mov_b32 v116, 0
    v_mov_b32 v117, 0
    v_mov_b32 v118, 0
    v_mov_b32 v119, 0
    v_mov_b32 v120, 0
    v_mov_b32 v121, 0
    v_mov_b32 v122, 0
    v_mov_b32 v123, 0
    v_mov_b32 v124, 0
    v_mov_b32 v125, 0
    v_mov_b32 v126, 0
    v_mov_b32 v127, 0
    s_mov_b32 s70, 0
    s_waitcnt lgkmcnt(0)
    s_barrier
    ds_read_b64_tr_b16 v[32:33], v10 offset:0
    ds_read_b64_tr_b16 v[34:35], v10 offset:4096
    ds_read_b64_tr_b16 v[36:37], v11 offset:0
    ds_read_b64_tr_b16 v[38:39], v11 offset:4096
    ds_read_b64_tr_b16 v[40:41], v12 offset:0
    ds_read_b64_tr_b16 v[42:43], v12 offset:4096
    ds_read_b64_tr_b16 v[44:45], v13 offset:0
    ds_read_b64_tr_b16 v[46:47], v13 offset:4096
    ds_read_b128 v[16:19], v8 offset:0
    ds_read_b128 v[20:23], v8 offset:2048
    ds_read_b128 v[24:27], v8 offset:4096
    ds_read_b128 v[28:31], v8 offset:6144
k1loop_4:
    ds_read_b64_tr_b16 v[48:49], v10 offset:8192
    ds_read_b64_tr_b16 v[50:51], v10 offset:12288
    ds_read_b64_tr_b16 v[52:53], v11 offset:8192
    ds_read_b64_tr_b16 v[54:55], v11 offset:12288
    ds_read_b64_tr_b16 v[56:57], v12 offset:8192
    ds_read_b64_tr_b16 v[58:59], v12 offset:12288
    ds_read_b64_tr_b16 v[60:61], v13 offset:8192
    ds_read_b64_tr_b16 v[62:63], v13 offset:12288
    s_waitcnt lgkmcnt(11)
    v_mfma_f32_16x16x32_bf16 v[64:67], v[32:35], v[16:19], v[64:67]
    v_mfma_f32_16x16x32_bf16 v[68:71], v[36:39], v[16:19], v[68:71]
    v_mfma_f32_16x16x32_bf16 v[72:75], v[40:43], v[16:19], v[72:75]
    v_mfma_f32_16x16x32_bf16 v[76:79], v[44:47], v[16:19], v[76:79]
    ds_read_b128 v[16:19], v9 offset:0
    s_waitcnt lgkmcnt(11)
    v_mfma_f32_16x16x32_bf16 v[80:83], v[32:35], v[20:23], v[80:83]
    v_mfma_f32_16x16x32_bf16 v[84:87], v[36:39], v[20:23], v[84:87]
    v_mfma_f32_16x16x32_bf16 v[88:91], v[40:43], v[20:23], v[88:91]
    v_mfma_f32_16x16x32_bf16 v[92:95], v[44:47], v[20:23], v[92:95]
    ds_read_b128 v[20:23], v9 offset:2048
    s_waitcnt lgkmcnt(11)
    v_mfma_f32_16x16x32_bf16 v[96:99], v[32:35], v[24:27], v[96:99]
    v_mfma_f32_16x16x32_bf16 v[100:103], v[36:39], v[24:27], v[100:103]
    v_mfma_f32_16x16x32_bf16 v[104:107], v[40:43], v[24:27], v[104:107]
    v_mfma_f32_16x16x32_bf16 v[108:111], v[44:47], v[24:27], v[108:111]
    ds_read_b128 v[24:27], v9 offset:4096
    s_waitcnt lgkmcnt(11)
    v_mfma_f32_16x16x32_bf16 v[112:115], v[32:35], v[28:31], v[112:115]
    v_mfma_f32_16x16x32_bf16 v[116:119], v[36:39], v[28:31], v[116:119]
    v_mfma_f32_16x16x32_bf16 v[120:123], v[40:43], v[28:31], v[120:123]
    v_mfma_f32_16x16x32_bf16 v[124:127], v[44:47], v[28:31], v[124:127]
    ds_read_b128 v[28:31], v9 offset:6144
    s_waitcnt lgkmcnt(0)
    s_barrier
    v_xor_b32 v8, 16384, v8
    v_xor_b32 v9, 16384, v9
    v_add_u32 v10, 32768, v10
    v_add_u32 v11, 32768, v11
    v_add_u32 v12, 32768, v12
    v_add_u32 v13, 32768, v13
    v_and_b32 v10, 0x1ffff, v10
    v_and_b32 v11, 0x1ffff, v11
    v_and_b32 v12, 0x1ffff, v12
    v_and_b32 v13, 0x1ffff, v13
    ds_read_b64_tr_b16 v[32:33], v10 offset:0
    ds_read_b64_tr_b16 v[34:35], v10 offset:4096
    ds_read_b64_tr_b16 v[36:37], v11 offset:0
    ds_read_b64_tr_b16 v[38:39], v11 offset:4096
    ds_read_b64_tr_b16 v[40:41], v12 offset:0
    ds_read_b64_tr_b16 v[42:43], v12 offset:4096
    ds_read_b64_tr_b16 v[44:45], v13 offset:0
    ds_read_b64_tr_b16 v[46:47], v13 offset:4096
    s_waitcnt lgkmcnt(11)
    v_mfma_f32_16x16x32_bf16 v[64:67], v[48:51], v[16:19], v[64:67]
    v_mfma_f32_16x16x32_bf16 v[68:71], v[52:55], v[16:19], v[68:71]
    v_mfma_f32_16x16x32_bf16 v[72:75], v[56:59], v[16:19], v[72:75]
    v_mfma_f32_16x16x32_bf16 v[76:79], v[60:63], v[16:19], v[76:79]
    ds_read_b128 v[16:19], v8 offset:0
    s_waitcnt lgkmcnt(11)
    v_mfma_f32_16x16x32_bf16 v[80:83], v[48:51], v[20:23], v[80:83]
    v_mfma_f32_16x16x32_bf16 v[84:87], v[52:55], v[20:23], v[84:87]
    v_mfma_f32_16x16x32_bf16 v[88:91], v[56:59], v[20:23], v[88:91]
    v_mfma_f32_16x16x32_bf16 v[92:95], v[60:63], v[20:23], v[92:95]
    ds_read_b128 v[20:23], v8 offset:2048
    s_waitcnt lgkmcnt(11)
    v_mfma_f32_16x16x32_bf16 v[96:99], v[48:51], v[24:27], v[96:99]
    v_mfma_f32_16x16x32_bf16 v[100:103], v[52:55], v[24:27], v[100:103]
    v_mfma_f32_16x16x32_bf16 v[104:107], v[56:59], v[24:27], v[104:107]
    v_mfma_f32_16x16x32_bf16 v[108:111], v[60:63], v[24:27], v[108:111]
    ds_read_b128 v[24:27], v8 offset:4096
    s_waitcnt lgkmcnt(11)
    v_mfma_f32_16x16x32_bf16 v[112:115], v[48:51], v[28:31], v[112:115]
    v_mfma_f32_16x16x32_bf16 v[116:119], v[52:55], v[28:31], v[116:119]
    v_mfma_f32_16x16x32_bf16 v[120:123], v[56:59], v[28:31], v[120:123]
    v_mfma_f32_16x16x32_bf16 v[124:127], v[60:63], v[28:31], v[124:127]
    ds_read_b128 v[28:31], v8 offset:6144
    s_add_u32 s70, s70, 1
    s_cmp_lt_u32 s70, 9
    s_cbranch_scc1 k1loop_4
    ds_read_b64_tr_b16 v[48:49], v10 offset:8192
    ds_read_b64_tr_b16 v[50:51], v10 offset:12288
    ds_read_b64_tr_b16 v[52:53], v11 offset:8192
    ds_read_b64_tr_b16 v[54:55], v11 offset:12288
    ds_read_b64_tr_b16 v[56:57], v12 offset:8192
    ds_read_b64_tr_b16 v[58:59], v12 offset:12288
    ds_read_b64_tr_b16 v[60:61], v13 offset:8192
    ds_read_b64_tr_b16 v[62:63], v13 offset:12288
    s_waitcnt lgkmcnt(11)
    v_mfma_f32_16x16x32_bf16 v[64:67], v[32:35], v[16:19], v[64:67]
    v_mfma_f32_16x16x32_bf16 v[68:71], v[36:39], v[16:19], v[68:71]
    v_mfma_f32_16x16x32_bf16 v[72:75], v[40:43], v[16:19], v[72:75]
    v_mfma_f32_16x16x32_bf16 v[76:79], v[44:47], v[16:19], v[76:79]
    ds_read_b128 v[16:19], v9 offset:0
    s_waitcnt lgkmcnt(11)
    v_mfma_f32_16x16x32_bf16 v[80:83], v[32:35], v[20:23], v[80:83]
    v_mfma_f32_16x16x32_bf16 v[84:87], v[36:39], v[20:23], v[84:87]
    v_mfma_f32_16x16x32_bf16 v[88:91], v[40:43], v[20:23], v[88:91]
    v_mfma_f32_16x16x32_bf16 v[92:95], v[44:47], v[20:23], v[92:95]
    ds_read_b128 v[20:23], v9 offset:2048
    s_waitcnt lgkmcnt(11)
    v_mfma_f32_16x16x32_bf16 v[96:99], v[32:35], v[24:27], v[96:99]
    v_mfma_f32_16x16x32_bf16 v[100:103], v[36:39], v[24:27], v[100:103]
    v_mfma_f32_16x16x32_bf16 v[104:107], v[40:43], v[24:27], v[104:107]
    v_mfma_f32_16x16x32_bf16 v[108:111], v[44:47], v[24:27], v[108:111]
    ds_read_b128 v[24:27], v9 offset:4096
    s_waitcnt lgkmcnt(11)
    v_mfma_f32_16x16x32_bf16 v[112:115], v[32:35], v[28:31], v[112:115]
    v_mfma_f32_16x16x32_bf16 v[116:119], v[36:39], v[28:31], v[116:119]
    v_mfma_f32_16x16x32_bf16 v[120:123], v[40:43], v[28:31], v[120:123]
    v_mfma_f32_16x16x32_bf16 v[124:127], v[44:47], v[28:31], v[124:127]
    ds_read_b128 v[28:31], v9 offset:6144
    s_waitcnt lgkmcnt(0)
    s_waitcnt lgkmcnt(3)
    v_mfma_f32_16x16x32_bf16 v[64:67], v[48:51], v[16:19], v[64:67]
    v_mfma_f32_16x16x32_bf16 v[68:71], v[52:55], v[16:19], v[68:71]
    v_mfma_f32_16x16x32_bf16 v[72:75], v[56:59], v[16:19], v[72:75]
    v_mfma_f32_16x16x32_bf16 v[76:79], v[60:63], v[16:19], v[76:79]
    s_waitcnt lgkmcnt(2)
    v_mfma_f32_16x16x32_bf16 v[80:83], v[48:51], v[20:23], v[80:83]
    v_mfma_f32_16x16x32_bf16 v[84:87], v[52:55], v[20:23], v[84:87]
    v_mfma_f32_16x16x32_bf16 v[88:91], v[56:59], v[20:23], v[88:91]
    v_mfma_f32_16x16x32_bf16 v[92:95], v[60:63], v[20:23], v[92:95]
    s_waitcnt lgkmcnt(1)
    v_mfma_f32_16x16x32_bf16 v[96:99], v[48:51], v[24:27], v[96:99]
    v_mfma_f32_16x16x32_bf16 v[100:103], v[52:55], v[24:27], v[100:103]
    v_mfma_f32_16x16x32_bf16 v[104:107], v[56:59], v[24:27], v[104:107]
    v_mfma_f32_16x16x32_bf16 v[108:111], v[60:63], v[24:27], v[108:111]
    s_waitcnt lgkmcnt(0)
    v_mfma_f32_16x16x32_bf16 v[112:115], v[48:51], v[28:31], v[112:115]
    v_mfma_f32_16x16x32_bf16 v[116:119], v[52:55], v[28:31], v[116:119]
    v_mfma_f32_16x16x32_bf16 v[120:123], v[56:59], v[28:31], v[120:123]
    v_mfma_f32_16x16x32_bf16 v[124:127], v[60:63], v[28:31], v[124:127]
    s_nop 9
    s_mov_b32 s52, 0x3fb8aa3b
    s_mov_b32 s53, 0x3fb8aa3b
    s_mov_b32 s66, 0x358637bd
    s_mov_b32 s67, 0x358637bd
    s_mov_b32 s54, 0x3ea52b5c
    s_mov_b32 s68, 0x3ea52b5c
    s_mov_b32 s69, 0x3ea52b5c
    v_and_b32 v2, 15, v1
    v_lshrrev_b32 v3, 4, v1
    s_cmp_eq_u32 s40, 1
    s_cbranch_scc1 k1_kernel_Bk
    s_cmp_eq_u32 s49, 1
    s_cbranch_scc1 k1_kernel_Bq
    v_pk_mul_f32 v[32:33], v[64:65], s[52:53]
    v_pk_mul_f32 v[34:35], v[66:67], s[52:53]
    v_pk_mul_f32 v[36:37], v[68:69], s[52:53]
    v_pk_mul_f32 v[38:39], v[70:71], s[52:53]
    v_pk_mul_f32 v[40:41], v[72:73], s[52:53]
    v_pk_mul_f32 v[42:43], v[74:75], s[52:53]
    v_pk_mul_f32 v[44:45], v[76:77], s[52:53]
    v_pk_mul_f32 v[46:47], v[78:79], s[52:53]
    v_exp_f32_e64 v32, v32 clamp
    v_exp_f32_e64 v33, v33 clamp
    v_exp_f32_e64 v34, v34 clamp
    v_exp_f32_e64 v35, v35 clamp
    v_exp_f32_e64 v36, v36 clamp
    v_exp_f32_e64 v37, v37 clamp
    v_exp_f32_e64 v38, v38 clamp
    v_exp_f32_e64 v39, v39 clamp
    v_exp_f32_e64 v40, v40 clamp
    v_exp_f32_e64 v41, v41 clamp
    v_exp_f32_e64 v42, v42 clamp
    v_exp_f32_e64 v43, v43 clamp
    v_exp_f32_e64 v44, v44 clamp
    v_exp_f32_e64 v45, v45 clamp
    v_exp_f32_e64 v46, v46 clamp
    v_exp_f32_e64 v47, v47 clamp
    v_max_f32 v64, 0, v64
    v_max_f32 v65, 0, v65
    v_max_f32 v66, 0, v66
    v_max_f32 v67, 0, v67
    v_max_f32 v68, 0, v68
    v_max_f32 v69, 0, v69
    v_max_f32 v70, 0, v70
    v_max_f32 v71, 0, v71
    v_max_f32 v72, 0, v72
    v_max_f32 v73, 0, v73
    v_max_f32 v74, 0, v74
    v_max_f32 v75, 0, v75
    v_max_f32 v76, 0, v76
    v_max_f32 v77, 0, v77
    v_max_f32 v78, 0, v78
    v_max_f32 v79, 0, v79
    v_pk_add_f32 v[32:33], v[32:33], s[66:67]
    v_pk_add_f32 v[34:35], v[34:35], s[66:67]
    v_pk_add_f32 v[36:37], v[36:37], s[66:67]
    v_pk_add_f32 v[38:39], v[38:39], s[66:67]
    v_pk_add_f32 v[40:41], v[40:41], s[66:67]
    v_pk_add_f32 v[42:43], v[42:43], s[66:67]
    v_pk_add_f32 v[44:45], v[44:45], s[66:67]
    v_pk_add_f32 v[46:47], v[46:47], s[66:67]
    v_pk_add_f32 v[64:65], v[64:65], v[32:33]
    v_pk_add_f32 v[66:67], v[66:67], v[34:35]
    v_pk_add_f32 v[68:69], v[68:69], v[36:37]
    v_pk_add_f32 v[70:71], v[70:71], v[38:39]
    v_pk_add_f32 v[72:73], v[72:73], v[40:41]
    v_pk_add_f32 v[74:75], v[74:75], v[42:43]
    v_pk_add_f32 v[76:77], v[76:77], v[44:45]
    v_pk_add_f32 v[78:79], v[78:79], v[46:47]
    v_pk_mul_f32 v[32:33], v[80:81], s[52:53]
    v_pk_mul_f32 v[34:35], v[82:83], s[52:53]
    v_pk_mul_f32 v[36:37], v[84:85], s[52:53]
    v_pk_mul_f32 v[38:39], v[86:87], s[52:53]
    v_pk_mul_f32 v[40:41], v[88:89], s[52:53]
    v_pk_mul_f32 v[42:43], v[90:91], s[52:53]
    v_pk_mul_f32 v[44:45], v[92:93], s[52:53]
    v_pk_mul_f32 v[46:47], v[94:95], s[52:53]
    v_exp_f32_e64 v32, v32 clamp
    v_exp_f32_e64 v33, v33 clamp
    v_exp_f32_e64 v34, v34 clamp
    v_exp_f32_e64 v35, v35 clamp
    v_exp_f32_e64 v36, v36 clamp
    v_exp_f32_e64 v37, v37 clamp
    v_exp_f32_e64 v38, v38 clamp
    v_exp_f32_e64 v39, v39 clamp
    v_exp_f32_e64 v40, v40 clamp
    v_exp_f32_e64 v41, v41 clamp
    v_exp_f32_e64 v42, v42 clamp
    v_exp_f32_e64 v43, v43 clamp
    v_exp_f32_e64 v44, v44 clamp
    v_exp_f32_e64 v45, v45 clamp
    v_exp_f32_e64 v46, v46 clamp
    v_exp_f32_e64 v47, v47 clamp
    v_max_f32 v80, 0, v80
    v_max_f32 v81, 0, v81
    v_max_f32 v82, 0, v82
    v_max_f32 v83, 0, v83
    v_max_f32 v84, 0, v84
    v_max_f32 v85, 0, v85
    v_max_f32 v86, 0, v86
    v_max_f32 v87, 0, v87
    v_max_f32 v88, 0, v88
    v_max_f32 v89, 0, v89
    v_max_f32 v90, 0, v90
    v_max_f32 v91, 0, v91
    v_max_f32 v92, 0, v92
    v_max_f32 v93, 0, v93
    v_max_f32 v94, 0, v94
    v_max_f32 v95, 0, v95
    v_pk_add_f32 v[32:33], v[32:33], s[66:67]
    v_pk_add_f32 v[34:35], v[34:35], s[66:67]
    v_pk_add_f32 v[36:37], v[36:37], s[66:67]
    v_pk_add_f32 v[38:39], v[38:39], s[66:67]
    v_pk_add_f32 v[40:41], v[40:41], s[66:67]
    v_pk_add_f32 v[42:43], v[42:43], s[66:67]
    v_pk_add_f32 v[44:45], v[44:45], s[66:67]
    v_pk_add_f32 v[46:47], v[46:47], s[66:67]
    v_pk_add_f32 v[80:81], v[80:81], v[32:33]
    v_pk_add_f32 v[82:83], v[82:83], v[34:35]
    v_pk_add_f32 v[84:85], v[84:85], v[36:37]
    v_pk_add_f32 v[86:87], v[86:87], v[38:39]
    v_pk_add_f32 v[88:89], v[88:89], v[40:41]
    v_pk_add_f32 v[90:91], v[90:91], v[42:43]
    v_pk_add_f32 v[92:93], v[92:93], v[44:45]
    v_pk_add_f32 v[94:95], v[94:95], v[46:47]
    v_pk_mul_f32 v[32:33], v[96:97], s[52:53]
    v_pk_mul_f32 v[34:35], v[98:99], s[52:53]
    v_pk_mul_f32 v[36:37], v[100:101], s[52:53]
    v_pk_mul_f32 v[38:39], v[102:103], s[52:53]
    v_pk_mul_f32 v[40:41], v[104:105], s[52:53]
    v_pk_mul_f32 v[42:43], v[106:107], s[52:53]
    v_pk_mul_f32 v[44:45], v[108:109], s[52:53]
    v_pk_mul_f32 v[46:47], v[110:111], s[52:53]
    v_exp_f32_e64 v32, v32 clamp
    v_exp_f32_e64 v33, v33 clamp
    v_exp_f32_e64 v34, v34 clamp
    v_exp_f32_e64 v35, v35 clamp
    v_exp_f32_e64 v36, v36 clamp
    v_exp_f32_e64 v37, v37 clamp
    v_exp_f32_e64 v38, v38 clamp
    v_exp_f32_e64 v39, v39 clamp
    v_exp_f32_e64 v40, v40 clamp
    v_exp_f32_e64 v41, v41 clamp
    v_exp_f32_e64 v42, v42 clamp
    v_exp_f32_e64 v43, v43 clamp
    v_exp_f32_e64 v44, v44 clamp
    v_exp_f32_e64 v45, v45 clamp
    v_exp_f32_e64 v46, v46 clamp
    v_exp_f32_e64 v47, v47 clamp
    v_max_f32 v96, 0, v96
    v_max_f32 v97, 0, v97
    v_max_f32 v98, 0, v98
    v_max_f32 v99, 0, v99
    v_max_f32 v100, 0, v100
    v_max_f32 v101, 0, v101
    v_max_f32 v102, 0, v102
    v_max_f32 v103, 0, v103
    v_max_f32 v104, 0, v104
    v_max_f32 v105, 0, v105
    v_max_f32 v106, 0, v106
    v_max_f32 v107, 0, v107
    v_max_f32 v108, 0, v108
    v_max_f32 v109, 0, v109
    v_max_f32 v110, 0, v110
    v_max_f32 v111, 0, v111
    v_pk_add_f32 v[32:33], v[32:33], s[66:67]
    v_pk_add_f32 v[34:35], v[34:35], s[66:67]
    v_pk_add_f32 v[36:37], v[36:37], s[66:67]
    v_pk_add_f32 v[38:39], v[38:39], s[66:67]
    v_pk_add_f32 v[40:41], v[40:41], s[66:67]
    v_pk_add_f32 v[42:43], v[42:43], s[66:67]
    v_pk_add_f32 v[44:45], v[44:45], s[66:67]
    v_pk_add_f32 v[46:47], v[46:47], s[66:67]
    v_pk_add_f32 v[96:97], v[96:97], v[32:33]
    v_pk_add_f32 v[98:99], v[98:99], v[34:35]
    v_pk_add_f32 v[100:101], v[100:101], v[36:37]
    v_pk_add_f32 v[102:103], v[102:103], v[38:39]
    v_pk_add_f32 v[104:105], v[104:105], v[40:41]
    v_pk_add_f32 v[106:107], v[106:107], v[42:43]
    v_pk_add_f32 v[108:109], v[108:109], v[44:45]
    v_pk_add_f32 v[110:111], v[110:111], v[46:47]
    v_pk_mul_f32 v[32:33], v[112:113], s[52:53]
    v_pk_mul_f32 v[34:35], v[114:115], s[52:53]
    v_pk_mul_f32 v[36:37], v[116:117], s[52:53]
    v_pk_mul_f32 v[38:39], v[118:119], s[52:53]
    v_pk_mul_f32 v[40:41], v[120:121], s[52:53]
    v_pk_mul_f32 v[42:43], v[122:123], s[52:53]
    v_pk_mul_f32 v[44:45], v[124:125], s[52:53]
    v_pk_mul_f32 v[46:47], v[126:127], s[52:53]
    v_exp_f32_e64 v32, v32 clamp
    v_exp_f32_e64 v33, v33 clamp
    v_exp_f32_e64 v34, v34 clamp
    v_exp_f32_e64 v35, v35 clamp
    v_exp_f32_e64 v36, v36 clamp
    v_exp_f32_e64 v37, v37 clamp
    v_exp_f32_e64 v38, v38 clamp
    v_exp_f32_e64 v39, v39 clamp
    v_exp_f32_e64 v40, v40 clamp
    v_exp_f32_e64 v41, v41 clamp
    v_exp_f32_e64 v42, v42 clamp
    v_exp_f32_e64 v43, v43 clamp
    v_exp_f32_e64 v44, v44 clamp
    v_exp_f32_e64 v45, v45 clamp
    v_exp_f32_e64 v46, v46 clamp
    v_exp_f32_e64 v47, v47 clamp
    v_max_f32 v112, 0, v112
    v_max_f32 v113, 0, v113
    v_max_f32 v114, 0, v114
    v_max_f32 v115, 0, v115
    v_max_f32 v116, 0, v116
    v_max_f32 v117, 0, v117
    v_max_f32 v118, 0, v118
    v_max_f32 v119, 0, v119
    v_max_f32 v120, 0, v120
    v_max_f32 v121, 0, v121
    v_max_f32 v122, 0, v122
    v_max_f32 v123, 0, v123
    v_max_f32 v124, 0, v124
    v_max_f32 v125, 0, v125
    v_max_f32 v126, 0, v126
    v_max_f32 v127, 0, v127
    v_pk_add_f32 v[32:33], v[32:33], s[66:67]
    v_pk_add_f32 v[34:35], v[34:35], s[66:67]
    v_pk_add_f32 v[36:37], v[36:37], s[66:67]
    v_pk_add_f32 v[38:39], v[38:39], s[66:67]
    v_pk_add_f32 v[40:41], v[40:41], s[66:67]
    v_pk_add_f32 v[42:43], v[42:43], s[66:67]
    v_pk_add_f32 v[44:45], v[44:45], s[66:67]
    v_pk_add_f32 v[46:47], v[46:47], s[66:67]
    v_pk_add_f32 v[112:113], v[112:113], v[32:33]
    v_pk_add_f32 v[114:115], v[114:115], v[34:35]
    v_pk_add_f32 v[116:117], v[116:117], v[36:37]
    v_pk_add_f32 v[118:119], v[118:119], v[38:39]
    v_pk_add_f32 v[120:121], v[120:121], v[40:41]
    v_pk_add_f32 v[122:123], v[122:123], v[42:43]
    v_pk_add_f32 v[124:125], v[124:125], v[44:45]
    v_pk_add_f32 v[126:127], v[126:127], v[46:47]
    s_lshl_b32 s56, s41, 5
    s_and_b32 s57, s17, 1
    s_lshl_b32 s57, s57, 4
    s_add_u32 s56, s56, s57
    v_add_u32 v4, s56, v3
    s_lshl_b32 s57, s14, 2
    s_lshl_b32 s58, s16, 1
    s_add_u32 s57, s57, s58
    v_mov_b32 v5, v2
    s_mov_b32 s59, 5242880
    v_add_u32 v6, 0, v4
    v_mul_u32_u24 v7, 205, v6
    v_lshrrev_b32 v7, 10, v7
    v_mul_u32_u24 v8, 5, v7
    v_sub_u32 v8, v6, v8
    v_lshlrev_b32 v9, 6, v7
    v_add_u32 v9, s57, v9
    v_mul_u32_u24 v9, 1280, v9
    v_and_b32 v10, 1, v8
    v_lshrrev_b32 v11, 1, v8
    v_lshlrev_b32 v10, 9, v10
    v_lshl_add_u32 v10, v11, 3, v10
    v_lshl_add_u32 v10, v5, 4, v10
    v_lshlrev_b32 v11, 3, v5
    v_add_u32 v11, 1024, v11
    v_cmp_eq_u32 vcc, 4, v8
    s_nop 1
    v_cndmask_b32 v12, v10, v11, vcc
    v_add_u32 v10, 256, v10
    v_add_u32 v11, 128, v11
    v_cndmask_b32 v13, v10, v11, vcc
    v_add_u32 v12, v12, v9
    v_add_u32 v13, v13, v9
    v_cvt_pk_bf16_f32 v32, v64, v65
    v_cvt_pk_bf16_f32 v33, v66, v67
    buffer_store_dwordx2 v[32:33], v12, s[28:31], s59 offen offset:0
    v_cvt_pk_bf16_f32 v34, v80, v81
    v_cvt_pk_bf16_f32 v35, v82, v83
    buffer_store_dwordx2 v[34:35], v13, s[28:31], s59 offen offset:0
    v_cvt_pk_bf16_f32 v36, v96, v97
    v_cvt_pk_bf16_f32 v37, v98, v99
    buffer_store_dwordx2 v[36:37], v12, s[28:31], s59 offen offset:1280
    v_cvt_pk_bf16_f32 v38, v112, v113
    v_cvt_pk_bf16_f32 v39, v114, v115
    buffer_store_dwordx2 v[38:39], v13, s[28:31], s59 offen offset:1280
    v_add_u32 v6, 4, v4
    v_mul_u32_u24 v7, 205, v6
    v_lshrrev_b32 v7, 10, v7
    v_mul_u32_u24 v8, 5, v7
    v_sub_u32 v8, v6, v8
    v_lshlrev_b32 v9, 6, v7
    v_add_u32 v9, s57, v9
    v_mul_u32_u24 v9, 1280, v9
    v_and_b32 v10, 1, v8
    v_lshrrev_b32 v11, 1, v8
    v_lshlrev_b32 v10, 9, v10
    v_lshl_add_u32 v10, v11, 3, v10
    v_lshl_add_u32 v10, v5, 4, v10
    v_lshlrev_b32 v11, 3, v5
    v_add_u32 v11, 1024, v11
    v_cmp_eq_u32 vcc, 4, v8
    s_nop 1
    v_cndmask_b32 v12, v10, v11, vcc
    v_add_u32 v10, 256, v10
    v_add_u32 v11, 128, v11
    v_cndmask_b32 v13, v10, v11, vcc
    v_add_u32 v12, v12, v9
    v_add_u32 v13, v13, v9
    v_cvt_pk_bf16_f32 v40, v68, v69
    v_cvt_pk_bf16_f32 v41, v70, v71
    buffer_store_dwordx2 v[40:41], v12, s[28:31], s59 offen offset:0
    v_cvt_pk_bf16_f32 v42, v84, v85
    v_cvt_pk_bf16_f32 v43, v86, v87
    buffer_store_dwordx2 v[42:43], v13, s[28:31], s59 offen offset:0
    v_cvt_pk_bf16_f32 v44, v100, v101
    v_cvt_pk_bf16_f32 v45, v102, v103
    buffer_store_dwordx2 v[44:45], v12, s[28:31], s59 offen offset:1280
    v_cvt_pk_bf16_f32 v46, v116, v117
    v_cvt_pk_bf16_f32 v47, v118, v119
    buffer_store_dwordx2 v[46:47], v13, s[28:31], s59 offen offset:1280
    v_add_u32 v6, 8, v4
    v_mul_u32_u24 v7, 205, v6
    v_lshrrev_b32 v7, 10, v7
    v_mul_u32_u24 v8, 5, v7
    v_sub_u32 v8, v6, v8
    v_lshlrev_b32 v9, 6, v7
    v_add_u32 v9, s57, v9
    v_mul_u32_u24 v9, 1280, v9
    v_and_b32 v10, 1, v8
    v_lshrrev_b32 v11, 1, v8
    v_lshlrev_b32 v10, 9, v10
    v_lshl_add_u32 v10, v11, 3, v10
    v_lshl_add_u32 v10, v5, 4, v10
    v_lshlrev_b32 v11, 3, v5
    v_add_u32 v11, 1024, v11
    v_cmp_eq_u32 vcc, 4, v8
    s_nop 1
    v_cndmask_b32 v12, v10, v11, vcc
    v_add_u32 v10, 256, v10
    v_add_u32 v11, 128, v11
    v_cndmask_b32 v13, v10, v11, vcc
    v_add_u32 v12, v12, v9
    v_add_u32 v13, v13, v9
    v_cvt_pk_bf16_f32 v48, v72, v73
    v_cvt_pk_bf16_f32 v49, v74, v75
    buffer_store_dwordx2 v[48:49], v12, s[28:31], s59 offen offset:0
    v_cvt_pk_bf16_f32 v50, v88, v89
    v_cvt_pk_bf16_f32 v51, v90, v91
    buffer_store_dwordx2 v[50:51], v13, s[28:31], s59 offen offset:0
    v_cvt_pk_bf16_f32 v52, v104, v105
    v_cvt_pk_bf16_f32 v53, v106, v107
    buffer_store_dwordx2 v[52:53], v12, s[28:31], s59 offen offset:1280
    v_cvt_pk_bf16_f32 v54, v120, v121
    v_cvt_pk_bf16_f32 v55, v122, v123
    buffer_store_dwordx2 v[54:55], v13, s[28:31], s59 offen offset:1280
    v_add_u32 v6, 12, v4
    v_mul_u32_u24 v7, 205, v6
    v_lshrrev_b32 v7, 10, v7
    v_mul_u32_u24 v8, 5, v7
    v_sub_u32 v8, v6, v8
    v_lshlrev_b32 v9, 6, v7
    v_add_u32 v9, s57, v9
    v_mul_u32_u24 v9, 1280, v9
    v_and_b32 v10, 1, v8
    v_lshrrev_b32 v11, 1, v8
    v_lshlrev_b32 v10, 9, v10
    v_lshl_add_u32 v10, v11, 3, v10
    v_lshl_add_u32 v10, v5, 4, v10
    v_lshlrev_b32 v11, 3, v5
    v_add_u32 v11, 1024, v11
    v_cmp_eq_u32 vcc, 4, v8
    s_nop 1
    v_cndmask_b32 v12, v10, v11, vcc
    v_add_u32 v10, 256, v10
    v_add_u32 v11, 128, v11
    v_cndmask_b32 v13, v10, v11, vcc
    v_add_u32 v12, v12, v9
    v_add_u32 v13, v13, v9
    v_cvt_pk_bf16_f32 v56, v76, v77
    v_cvt_pk_bf16_f32 v57, v78, v79
    buffer_store_dwordx2 v[56:57], v12, s[28:31], s59 offen offset:0
    v_cvt_pk_bf16_f32 v58, v92, v93
    v_cvt_pk_bf16_f32 v59, v94, v95
    buffer_store_dwordx2 v[58:59], v13, s[28:31], s59 offen offset:0
    v_cvt_pk_bf16_f32 v60, v108, v109
    v_cvt_pk_bf16_f32 v61, v110, v111
    buffer_store_dwordx2 v[60:61], v12, s[28:31], s59 offen offset:1280
    v_cvt_pk_bf16_f32 v62, v124, v125
    v_cvt_pk_bf16_f32 v63, v126, v127
    buffer_store_dwordx2 v[62:63], v13, s[28:31], s59 offen offset:1280
    s_branch k1_kernel_fin
k1_kernel_Bq:
    v_pk_mul_f32 v[64:65], v[64:65], s[68:69]
    v_pk_mul_f32 v[66:67], v[66:67], s[68:69]
    v_pk_mul_f32 v[68:69], v[68:69], s[68:69]
    v_pk_mul_f32 v[70:71], v[70:71], s[68:69]
    v_pk_mul_f32 v[72:73], v[72:73], s[68:69]
    v_pk_mul_f32 v[74:75], v[74:75], s[68:69]
    v_pk_mul_f32 v[76:77], v[76:77], s[68:69]
    v_pk_mul_f32 v[78:79], v[78:79], s[68:69]
    v_pk_mul_f32 v[80:81], v[80:81], s[68:69]
    v_pk_mul_f32 v[82:83], v[82:83], s[68:69]
    v_pk_mul_f32 v[84:85], v[84:85], s[68:69]
    v_pk_mul_f32 v[86:87], v[86:87], s[68:69]
    v_pk_mul_f32 v[88:89], v[88:89], s[68:69]
    v_pk_mul_f32 v[90:91], v[90:91], s[68:69]
    v_pk_mul_f32 v[92:93], v[92:93], s[68:69]
    v_pk_mul_f32 v[94:95], v[94:95], s[68:69]
    v_pk_mul_f32 v[96:97], v[96:97], s[68:69]
    v_pk_mul_f32 v[98:99], v[98:99], s[68:69]
    v_pk_mul_f32 v[100:101], v[100:101], s[68:69]
    v_pk_mul_f32 v[102:103], v[102:103], s[68:69]
    v_pk_mul_f32 v[104:105], v[104:105], s[68:69]
    v_pk_mul_f32 v[106:107], v[106:107], s[68:69]
    v_pk_mul_f32 v[108:109], v[108:109], s[68:69]
    v_pk_mul_f32 v[110:111], v[110:111], s[68:69]
    v_pk_mul_f32 v[112:113], v[112:113], s[68:69]
    v_pk_mul_f32 v[114:115], v[114:115], s[68:69]
    v_pk_mul_f32 v[116:117], v[116:117], s[68:69]
    v_pk_mul_f32 v[118:119], v[118:119], s[68:69]
    v_pk_mul_f32 v[120:121], v[120:121], s[68:69]
    v_pk_mul_f32 v[122:123], v[122:123], s[68:69]
    v_pk_mul_f32 v[124:125], v[124:125], s[68:69]
    v_pk_mul_f32 v[126:127], v[126:127], s[68:69]
    s_lshl_b32 s56, s41, 5
    s_and_b32 s57, s17, 1
    s_lshl_b32 s57, s57, 4
    s_add_u32 s56, s56, s57
    v_add_u32 v4, s56, v3
    s_lshl_b32 s57, s14, 2
    s_lshl_b32 s58, s16, 1
    s_add_u32 s57, s57, s58
    v_mov_b32 v5, v2
    s_mov_b32 s59, 0
    v_add_u32 v6, 0, v4
    v_mul_u32_u24 v7, 205, v6
    v_lshrrev_b32 v7, 10, v7
    v_mul_u32_u24 v8, 5, v7
    v_sub_u32 v8, v6, v8
    v_lshlrev_b32 v9, 6, v7
    v_add_u32 v9, s57, v9
    v_mul_u32_u24 v9, 1280, v9
    v_lshrrev_b32 v10, 1, v8
    v_and_b32 v11, 1, v8
    v_lshlrev_b32 v10, 9, v10
    v_lshl_add_u32 v10, v11, 3, v10
    v_lshl_add_u32 v10, v5, 4, v10
    v_lshlrev_b32 v11, 3, v5
    v_add_u32 v11, 1024, v11
    v_cmp_eq_u32 vcc, 4, v8
    s_nop 1
    v_cndmask_b32 v12, v10, v11, vcc
    v_add_u32 v10, 256, v10
    v_add_u32 v11, 128, v11
    v_cndmask_b32 v13, v10, v11, vcc
    v_add_u32 v12, v12, v9
    v_add_u32 v13, v13, v9
    v_cvt_pk_bf16_f32 v32, v64, v65
    v_cvt_pk_bf16_f32 v33, v66, v67
    buffer_store_dwordx2 v[32:33], v12, s[28:31], s59 offen offset:0
    v_cvt_pk_bf16_f32 v34, v80, v81
    v_cvt_pk_bf16_f32 v35, v82, v83
    buffer_store_dwordx2 v[34:35], v13, s[28:31], s59 offen offset:0
    v_cvt_pk_bf16_f32 v36, v96, v97
    v_cvt_pk_bf16_f32 v37, v98, v99
    buffer_store_dwordx2 v[36:37], v12, s[28:31], s59 offen offset:1280
    v_cvt_pk_bf16_f32 v38, v112, v113
    v_cvt_pk_bf16_f32 v39, v114, v115
    buffer_store_dwordx2 v[38:39], v13, s[28:31], s59 offen offset:1280
    v_mul_f32 v14, v64, v64
    v_fmac_f32 v14, v65, v65
    v_fmac_f32 v14, v66, v66
    v_fmac_f32 v14, v67, v67
    v_mul_f32 v15, v80, v80
    v_fmac_f32 v15, v81, v81
    v_fmac_f32 v15, v82, v82
    v_fmac_f32 v15, v83, v83
    v_mul_f32 v16, v96, v96
    v_fmac_f32 v16, v97, v97
    v_fmac_f32 v16, v98, v98
    v_fmac_f32 v16, v99, v99
    v_mul_f32 v17, v112, v112
    v_fmac_f32 v17, v113, v113
    v_fmac_f32 v17, v114, v114
    v_fmac_f32 v17, v115, v115
    v_max_f32 v14, v14, v15
    v_max3_f32 v14, v16, v17, v14
    s_nop 1
    v_max_f32_dpp v14, v14, v14 row_ror:8 row_mask:0xf bank_mask:0xf
    s_nop 1
    v_max_f32_dpp v14, v14, v14 row_ror:4 row_mask:0xf bank_mask:0xf
    s_nop 1
    v_max_f32_dpp v14, v14, v14 row_ror:2 row_mask:0xf bank_mask:0xf
    s_nop 1
    v_max_f32_dpp v14, v14, v14 row_ror:1 row_mask:0xf bank_mask:0xf
    s_lshl_b32 s60, s14, 1
    s_add_u32 s60, s60, s16
    s_lshl_b32 s60, s60, 2
    s_add_u32 s60, s60, 15728640
    v_lshlrev_b32 v15, 7, v6
    s_mov_b32 exec_lo, 0x00010001
    s_mov_b32 exec_hi, 0x00010001
    buffer_store_dword v14, v15, s[28:31], s60 offen
    s_mov_b64 exec, -1
    s_nop 0
    v_add_u32 v6, 4, v4
    v_mul_u32_u24 v7, 205, v6
    v_lshrrev_b32 v7, 10, v7
    v_mul_u32_u24 v8, 5, v7
    v_sub_u32 v8, v6, v8
    v_lshlrev_b32 v9, 6, v7
    v_add_u32 v9, s57, v9
    v_mul_u32_u24 v9, 1280, v9
    v_lshrrev_b32 v10, 1, v8
    v_and_b32 v11, 1, v8
    v_lshlrev_b32 v10, 9, v10
    v_lshl_add_u32 v10, v11, 3, v10
    v_lshl_add_u32 v10, v5, 4, v10
    v_lshlrev_b32 v11, 3, v5
    v_add_u32 v11, 1024, v11
    v_cmp_eq_u32 vcc, 4, v8
    s_nop 1
    v_cndmask_b32 v12, v10, v11, vcc
    v_add_u32 v10, 256, v10
    v_add_u32 v11, 128, v11
    v_cndmask_b32 v13, v10, v11, vcc
    v_add_u32 v12, v12, v9
    v_add_u32 v13, v13, v9
    v_cvt_pk_bf16_f32 v40, v68, v69
    v_cvt_pk_bf16_f32 v41, v70, v71
    buffer_store_dwordx2 v[40:41], v12, s[28:31], s59 offen offset:0
    v_cvt_pk_bf16_f32 v42, v84, v85
    v_cvt_pk_bf16_f32 v43, v86, v87
    buffer_store_dwordx2 v[42:43], v13, s[28:31], s59 offen offset:0
    v_cvt_pk_bf16_f32 v44, v100, v101
    v_cvt_pk_bf16_f32 v45, v102, v103
    buffer_store_dwordx2 v[44:45], v12, s[28:31], s59 offen offset:1280
    v_cvt_pk_bf16_f32 v46, v116, v117
    v_cvt_pk_bf16_f32 v47, v118, v119
    buffer_store_dwordx2 v[46:47], v13, s[28:31], s59 offen offset:1280
    v_mul_f32 v14, v68, v68
    v_fmac_f32 v14, v69, v69
    v_fmac_f32 v14, v70, v70
    v_fmac_f32 v14, v71, v71
    v_mul_f32 v15, v84, v84
    v_fmac_f32 v15, v85, v85
    v_fmac_f32 v15, v86, v86
    v_fmac_f32 v15, v87, v87
    v_mul_f32 v16, v100, v100
    v_fmac_f32 v16, v101, v101
    v_fmac_f32 v16, v102, v102
    v_fmac_f32 v16, v103, v103
    v_mul_f32 v17, v116, v116
    v_fmac_f32 v17, v117, v117
    v_fmac_f32 v17, v118, v118
    v_fmac_f32 v17, v119, v119
    v_max_f32 v14, v14, v15
    v_max3_f32 v14, v16, v17, v14
    s_nop 1
    v_max_f32_dpp v14, v14, v14 row_ror:8 row_mask:0xf bank_mask:0xf
    s_nop 1
    v_max_f32_dpp v14, v14, v14 row_ror:4 row_mask:0xf bank_mask:0xf
    s_nop 1
    v_max_f32_dpp v14, v14, v14 row_ror:2 row_mask:0xf bank_mask:0xf
    s_nop 1
    v_max_f32_dpp v14, v14, v14 row_ror:1 row_mask:0xf bank_mask:0xf
    s_lshl_b32 s60, s14, 1
    s_add_u32 s60, s60, s16
    s_lshl_b32 s60, s60, 2
    s_add_u32 s60, s60, 15728640
    v_lshlrev_b32 v15, 7, v6
    s_mov_b32 exec_lo, 0x00010001
    s_mov_b32 exec_hi, 0x00010001
    buffer_store_dword v14, v15, s[28:31], s60 offen
    s_mov_b64 exec, -1
    s_nop 0
    v_add_u32 v6, 8, v4
    v_mul_u32_u24 v7, 205, v6
    v_lshrrev_b32 v7, 10, v7
    v_mul_u32_u24 v8, 5, v7
    v_sub_u32 v8, v6, v8
    v_lshlrev_b32 v9, 6, v7
    v_add_u32 v9, s57, v9
    v_mul_u32_u24 v9, 1280, v9
    v_lshrrev_b32 v10, 1, v8
    v_and_b32 v11, 1, v8
    v_lshlrev_b32 v10, 9, v10
    v_lshl_add_u32 v10, v11, 3, v10
    v_lshl_add_u32 v10, v5, 4, v10
    v_lshlrev_b32 v11, 3, v5
    v_add_u32 v11, 1024, v11
    v_cmp_eq_u32 vcc, 4, v8
    s_nop 1
    v_cndmask_b32 v12, v10, v11, vcc
    v_add_u32 v10, 256, v10
    v_add_u32 v11, 128, v11
    v_cndmask_b32 v13, v10, v11, vcc
    v_add_u32 v12, v12, v9
    v_add_u32 v13, v13, v9
    v_cvt_pk_bf16_f32 v48, v72, v73
    v_cvt_pk_bf16_f32 v49, v74, v75
    buffer_store_dwordx2 v[48:49], v12, s[28:31], s59 offen offset:0
    v_cvt_pk_bf16_f32 v50, v88, v89
    v_cvt_pk_bf16_f32 v51, v90, v91
    buffer_store_dwordx2 v[50:51], v13, s[28:31], s59 offen offset:0
    v_cvt_pk_bf16_f32 v52, v104, v105
    v_cvt_pk_bf16_f32 v53, v106, v107
    buffer_store_dwordx2 v[52:53], v12, s[28:31], s59 offen offset:1280
    v_cvt_pk_bf16_f32 v54, v120, v121
    v_cvt_pk_bf16_f32 v55, v122, v123
    buffer_store_dwordx2 v[54:55], v13, s[28:31], s59 offen offset:1280
    v_mul_f32 v14, v72, v72
    v_fmac_f32 v14, v73, v73
    v_fmac_f32 v14, v74, v74
    v_fmac_f32 v14, v75, v75
    v_mul_f32 v15, v88, v88
    v_fmac_f32 v15, v89, v89
    v_fmac_f32 v15, v90, v90
    v_fmac_f32 v15, v91, v91
    v_mul_f32 v16, v104, v104
    v_fmac_f32 v16, v105, v105
    v_fmac_f32 v16, v106, v106
    v_fmac_f32 v16, v107, v107
    v_mul_f32 v17, v120, v120
    v_fmac_f32 v17, v121, v121
    v_fmac_f32 v17, v122, v122
    v_fmac_f32 v17, v123, v123
    v_max_f32 v14, v14, v15
    v_max3_f32 v14, v16, v17, v14
    s_nop 1
    v_max_f32_dpp v14, v14, v14 row_ror:8 row_mask:0xf bank_mask:0xf
    s_nop 1
    v_max_f32_dpp v14, v14, v14 row_ror:4 row_mask:0xf bank_mask:0xf
    s_nop 1
    v_max_f32_dpp v14, v14, v14 row_ror:2 row_mask:0xf bank_mask:0xf
    s_nop 1
    v_max_f32_dpp v14, v14, v14 row_ror:1 row_mask:0xf bank_mask:0xf
    s_lshl_b32 s60, s14, 1
    s_add_u32 s60, s60, s16
    s_lshl_b32 s60, s60, 2
    s_add_u32 s60, s60, 15728640
    v_lshlrev_b32 v15, 7, v6
    s_mov_b32 exec_lo, 0x00010001
    s_mov_b32 exec_hi, 0x00010001
    buffer_store_dword v14, v15, s[28:31], s60 offen
    s_mov_b64 exec, -1
    s_nop 0
    v_add_u32 v6, 12, v4
    v_mul_u32_u24 v7, 205, v6
    v_lshrrev_b32 v7, 10, v7
    v_mul_u32_u24 v8, 5, v7
    v_sub_u32 v8, v6, v8
    v_lshlrev_b32 v9, 6, v7
    v_add_u32 v9, s57, v9
    v_mul_u32_u24 v9, 1280, v9
    v_lshrrev_b32 v10, 1, v8
    v_and_b32 v11, 1, v8
    v_lshlrev_b32 v10, 9, v10
    v_lshl_add_u32 v10, v11, 3, v10
    v_lshl_add_u32 v10, v5, 4, v10
    v_lshlrev_b32 v11, 3, v5
    v_add_u32 v11, 1024, v11
    v_cmp_eq_u32 vcc, 4, v8
    s_nop 1
    v_cndmask_b32 v12, v10, v11, vcc
    v_add_u32 v10, 256, v10
    v_add_u32 v11, 128, v11
    v_cndmask_b32 v13, v10, v11, vcc
    v_add_u32 v12, v12, v9
    v_add_u32 v13, v13, v9
    v_cvt_pk_bf16_f32 v56, v76, v77
    v_cvt_pk_bf16_f32 v57, v78, v79
    buffer_store_dwordx2 v[56:57], v12, s[28:31], s59 offen offset:0
    v_cvt_pk_bf16_f32 v58, v92, v93
    v_cvt_pk_bf16_f32 v59, v94, v95
    buffer_store_dwordx2 v[58:59], v13, s[28:31], s59 offen offset:0
    v_cvt_pk_bf16_f32 v60, v108, v109
    v_cvt_pk_bf16_f32 v61, v110, v111
    buffer_store_dwordx2 v[60:61], v12, s[28:31], s59 offen offset:1280
    v_cvt_pk_bf16_f32 v62, v124, v125
    v_cvt_pk_bf16_f32 v63, v126, v127
    buffer_store_dwordx2 v[62:63], v13, s[28:31], s59 offen offset:1280
    v_mul_f32 v14, v76, v76
    v_fmac_f32 v14, v77, v77
    v_fmac_f32 v14, v78, v78
    v_fmac_f32 v14, v79, v79
    v_mul_f32 v15, v92, v92
    v_fmac_f32 v15, v93, v93
    v_fmac_f32 v15, v94, v94
    v_fmac_f32 v15, v95, v95
    v_mul_f32 v16, v108, v108
    v_fmac_f32 v16, v109, v109
    v_fmac_f32 v16, v110, v110
    v_fmac_f32 v16, v111, v111
    v_mul_f32 v17, v124, v124
    v_fmac_f32 v17, v125, v125
    v_fmac_f32 v17, v126, v126
    v_fmac_f32 v17, v127, v127
    v_max_f32 v14, v14, v15
    v_max3_f32 v14, v16, v17, v14
    s_nop 1
    v_max_f32_dpp v14, v14, v14 row_ror:8 row_mask:0xf bank_mask:0xf
    s_nop 1
    v_max_f32_dpp v14, v14, v14 row_ror:4 row_mask:0xf bank_mask:0xf
    s_nop 1
    v_max_f32_dpp v14, v14, v14 row_ror:2 row_mask:0xf bank_mask:0xf
    s_nop 1
    v_max_f32_dpp v14, v14, v14 row_ror:1 row_mask:0xf bank_mask:0xf
    s_lshl_b32 s60, s14, 1
    s_add_u32 s60, s60, s16
    s_lshl_b32 s60, s60, 2
    s_add_u32 s60, s60, 15728640
    v_lshlrev_b32 v15, 7, v6
    s_mov_b32 exec_lo, 0x00010001
    s_mov_b32 exec_hi, 0x00010001
    buffer_store_dword v14, v15, s[28:31], s60 offen
    s_mov_b64 exec, -1
    s_nop 0
    s_branch k1_kernel_fin
k1_kernel_Bk:
    s_lshl_b32 s56, s41, 5
    s_and_b32 s57, s17, 1
    s_lshl_b32 s57, s57, 4
    s_add_u32 s56, s56, s57
    v_add_u32 v4, s56, v3
    s_lshl_b32 s57, s14, 2
    s_lshl_b32 s58, s16, 1
    s_add_u32 s57, s57, s58
    v_and_b32 v5, 8, v2
    v_lshlrev_b32 v5, 1, v5
    v_and_b32 v6, 7, v2
    v_add_u32 v5, v5, v6
    s_mov_b32 s59, 2621440
    v_add_u32 v6, 0, v4
    v_mul_u32_u24 v7, 205, v6
    v_lshrrev_b32 v7, 10, v7
    v_mul_u32_u24 v8, 5, v7
    v_sub_u32 v8, v6, v8
    v_lshlrev_b32 v9, 6, v7
    v_add_u32 v9, s57, v9
    v_mul_u32_u24 v9, 1280, v9
    v_lshrrev_b32 v10, 1, v8
    v_and_b32 v11, 1, v8
    v_lshlrev_b32 v10, 9, v10
    v_lshl_add_u32 v10, v11, 3, v10
    v_lshl_add_u32 v10, v5, 4, v10
    v_lshlrev_b32 v11, 3, v5
    v_add_u32 v11, 1024, v11
    v_cmp_eq_u32 vcc, 4, v8
    s_nop 1
    v_cndmask_b32 v12, v10, v11, vcc
    v_add_u32 v10, 128, v10
    v_add_u32 v11, 64, v11
    v_cndmask_b32 v13, v10, v11, vcc
    v_add_u32 v12, v12, v9
    v_add_u32 v13, v13, v9
    v_cvt_pk_bf16_f32 v32, v64, v65
    v_cvt_pk_bf16_f32 v33, v66, v67
    buffer_store_dwordx2 v[32:33], v12, s[28:31], s59 offen offset:0
    v_cvt_pk_bf16_f32 v34, v80, v81
    v_cvt_pk_bf16_f32 v35, v82, v83
    buffer_store_dwordx2 v[34:35], v13, s[28:31], s59 offen offset:0
    v_cvt_pk_bf16_f32 v36, v96, v97
    v_cvt_pk_bf16_f32 v37, v98, v99
    buffer_store_dwordx2 v[36:37], v12, s[28:31], s59 offen offset:1280
    v_cvt_pk_bf16_f32 v38, v112, v113
    v_cvt_pk_bf16_f32 v39, v114, v115
    buffer_store_dwordx2 v[38:39], v13, s[28:31], s59 offen offset:1280
    v_mul_f32 v14, v64, v64
    v_fmac_f32 v14, v65, v65
    v_fmac_f32 v14, v66, v66
    v_fmac_f32 v14, v67, v67
    v_mul_f32 v15, v80, v80
    v_fmac_f32 v15, v81, v81
    v_fmac_f32 v15, v82, v82
    v_fmac_f32 v15, v83, v83
    v_mul_f32 v16, v96, v96
    v_fmac_f32 v16, v97, v97
    v_fmac_f32 v16, v98, v98
    v_fmac_f32 v16, v99, v99
    v_mul_f32 v17, v112, v112
    v_fmac_f32 v17, v113, v113
    v_fmac_f32 v17, v114, v114
    v_fmac_f32 v17, v115, v115
    v_max_f32 v14, v14, v15
    v_max3_f32 v14, v16, v17, v14
    s_nop 1
    v_max_f32_dpp v14, v14, v14 row_ror:8 row_mask:0xf bank_mask:0xf
    s_nop 1
    v_max_f32_dpp v14, v14, v14 row_ror:4 row_mask:0xf bank_mask:0xf
    s_nop 1
    v_max_f32_dpp v14, v14, v14 row_ror:2 row_mask:0xf bank_mask:0xf
    s_nop 1
    v_max_f32_dpp v14, v14, v14 row_ror:1 row_mask:0xf bank_mask:0xf
    s_lshl_b32 s60, s14, 1
    s_add_u32 s60, s60, s16
    s_lshl_b32 s60, s60, 2
    s_add_u32 s60, s60, 15749120
    v_lshlrev_b32 v15, 7, v6
    s_mov_b32 exec_lo, 0x00010001
    s_mov_b32 exec_hi, 0x00010001
    buffer_store_dword v14, v15, s[28:31], s60 offen
    s_mov_b64 exec, -1
    s_nop 0
    v_add_u32 v6, 4, v4
    v_mul_u32_u24 v7, 205, v6
    v_lshrrev_b32 v7, 10, v7
    v_mul_u32_u24 v8, 5, v7
    v_sub_u32 v8, v6, v8
    v_lshlrev_b32 v9, 6, v7
    v_add_u32 v9, s57, v9
    v_mul_u32_u24 v9, 1280, v9
    v_lshrrev_b32 v10, 1, v8
    v_and_b32 v11, 1, v8
    v_lshlrev_b32 v10, 9, v10
    v_lshl_add_u32 v10, v11, 3, v10
    v_lshl_add_u32 v10, v5, 4, v10
    v_lshlrev_b32 v11, 3, v5
    v_add_u32 v11, 1024, v11
    v_cmp_eq_u32 vcc, 4, v8
    s_nop 1
    v_cndmask_b32 v12, v10, v11, vcc
    v_add_u32 v10, 128, v10
    v_add_u32 v11, 64, v11
    v_cndmask_b32 v13, v10, v11, vcc
    v_add_u32 v12, v12, v9
    v_add_u32 v13, v13, v9
    v_cvt_pk_bf16_f32 v40, v68, v69
    v_cvt_pk_bf16_f32 v41, v70, v71
    buffer_store_dwordx2 v[40:41], v12, s[28:31], s59 offen offset:0
    v_cvt_pk_bf16_f32 v42, v84, v85
    v_cvt_pk_bf16_f32 v43, v86, v87
    buffer_store_dwordx2 v[42:43], v13, s[28:31], s59 offen offset:0
    v_cvt_pk_bf16_f32 v44, v100, v101
    v_cvt_pk_bf16_f32 v45, v102, v103
    buffer_store_dwordx2 v[44:45], v12, s[28:31], s59 offen offset:1280
    v_cvt_pk_bf16_f32 v46, v116, v117
    v_cvt_pk_bf16_f32 v47, v118, v119
    buffer_store_dwordx2 v[46:47], v13, s[28:31], s59 offen offset:1280
    v_mul_f32 v14, v68, v68
    v_fmac_f32 v14, v69, v69
    v_fmac_f32 v14, v70, v70
    v_fmac_f32 v14, v71, v71
    v_mul_f32 v15, v84, v84
    v_fmac_f32 v15, v85, v85
    v_fmac_f32 v15, v86, v86
    v_fmac_f32 v15, v87, v87
    v_mul_f32 v16, v100, v100
    v_fmac_f32 v16, v101, v101
    v_fmac_f32 v16, v102, v102
    v_fmac_f32 v16, v103, v103
    v_mul_f32 v17, v116, v116
    v_fmac_f32 v17, v117, v117
    v_fmac_f32 v17, v118, v118
    v_fmac_f32 v17, v119, v119
    v_max_f32 v14, v14, v15
    v_max3_f32 v14, v16, v17, v14
    s_nop 1
    v_max_f32_dpp v14, v14, v14 row_ror:8 row_mask:0xf bank_mask:0xf
    s_nop 1
    v_max_f32_dpp v14, v14, v14 row_ror:4 row_mask:0xf bank_mask:0xf
    s_nop 1
    v_max_f32_dpp v14, v14, v14 row_ror:2 row_mask:0xf bank_mask:0xf
    s_nop 1
    v_max_f32_dpp v14, v14, v14 row_ror:1 row_mask:0xf bank_mask:0xf
    s_lshl_b32 s60, s14, 1
    s_add_u32 s60, s60, s16
    s_lshl_b32 s60, s60, 2
    s_add_u32 s60, s60, 15749120
    v_lshlrev_b32 v15, 7, v6
    s_mov_b32 exec_lo, 0x00010001
    s_mov_b32 exec_hi, 0x00010001
    buffer_store_dword v14, v15, s[28:31], s60 offen
    s_mov_b64 exec, -1
    s_nop 0
    v_add_u32 v6, 8, v4
    v_mul_u32_u24 v7, 205, v6
    v_lshrrev_b32 v7, 10, v7
    v_mul_u32_u24 v8, 5, v7
    v_sub_u32 v8, v6, v8
    v_lshlrev_b32 v9, 6, v7
    v_add_u32 v9, s57, v9
    v_mul_u32_u24 v9, 1280, v9
    v_lshrrev_b32 v10, 1, v8
    v_and_b32 v11, 1, v8
    v_lshlrev_b32 v10, 9, v10
    v_lshl_add_u32 v10, v11, 3, v10
    v_lshl_add_u32 v10, v5, 4, v10
    v_lshlrev_b32 v11, 3, v5
    v_add_u32 v11, 1024, v11
    v_cmp_eq_u32 vcc, 4, v8
    s_nop 1
    v_cndmask_b32 v12, v10, v11, vcc
    v_add_u32 v10, 128, v10
    v_add_u32 v11, 64, v11
    v_cndmask_b32 v13, v10, v11, vcc
    v_add_u32 v12, v12, v9
    v_add_u32 v13, v13, v9
    v_cvt_pk_bf16_f32 v48, v72, v73
    v_cvt_pk_bf16_f32 v49, v74, v75
    buffer_store_dwordx2 v[48:49], v12, s[28:31], s59 offen offset:0
    v_cvt_pk_bf16_f32 v50, v88, v89
    v_cvt_pk_bf16_f32 v51, v90, v91
    buffer_store_dwordx2 v[50:51], v13, s[28:31], s59 offen offset:0
    v_cvt_pk_bf16_f32 v52, v104, v105
    v_cvt_pk_bf16_f32 v53, v106, v107
    buffer_store_dwordx2 v[52:53], v12, s[28:31], s59 offen offset:1280
    v_cvt_pk_bf16_f32 v54, v120, v121
    v_cvt_pk_bf16_f32 v55, v122, v123
    buffer_store_dwordx2 v[54:55], v13, s[28:31], s59 offen offset:1280
    v_mul_f32 v14, v72, v72
    v_fmac_f32 v14, v73, v73
    v_fmac_f32 v14, v74, v74
    v_fmac_f32 v14, v75, v75
    v_mul_f32 v15, v88, v88
    v_fmac_f32 v15, v89, v89
    v_fmac_f32 v15, v90, v90
    v_fmac_f32 v15, v91, v91
    v_mul_f32 v16, v104, v104
    v_fmac_f32 v16, v105, v105
    v_fmac_f32 v16, v106, v106
    v_fmac_f32 v16, v107, v107
    v_mul_f32 v17, v120, v120
    v_fmac_f32 v17, v121, v121
    v_fmac_f32 v17, v122, v122
    v_fmac_f32 v17, v123, v123
    v_max_f32 v14, v14, v15
    v_max3_f32 v14, v16, v17, v14
    s_nop 1
    v_max_f32_dpp v14, v14, v14 row_ror:8 row_mask:0xf bank_mask:0xf
    s_nop 1
    v_max_f32_dpp v14, v14, v14 row_ror:4 row_mask:0xf bank_mask:0xf
    s_nop 1
    v_max_f32_dpp v14, v14, v14 row_ror:2 row_mask:0xf bank_mask:0xf
    s_nop 1
    v_max_f32_dpp v14, v14, v14 row_ror:1 row_mask:0xf bank_mask:0xf
    s_lshl_b32 s60, s14, 1
    s_add_u32 s60, s60, s16
    s_lshl_b32 s60, s60, 2
    s_add_u32 s60, s60, 15749120
    v_lshlrev_b32 v15, 7, v6
    s_mov_b32 exec_lo, 0x00010001
    s_mov_b32 exec_hi, 0x00010001
    buffer_store_dword v14, v15, s[28:31], s60 offen
    s_mov_b64 exec, -1
    s_nop 0
    v_add_u32 v6, 12, v4
    v_mul_u32_u24 v7, 205, v6
    v_lshrrev_b32 v7, 10, v7
    v_mul_u32_u24 v8, 5, v7
    v_sub_u32 v8, v6, v8
    v_lshlrev_b32 v9, 6, v7
    v_add_u32 v9, s57, v9
    v_mul_u32_u24 v9, 1280, v9
    v_lshrrev_b32 v10, 1, v8
    v_and_b32 v11, 1, v8
    v_lshlrev_b32 v10, 9, v10
    v_lshl_add_u32 v10, v11, 3, v10
    v_lshl_add_u32 v10, v5, 4, v10
    v_lshlrev_b32 v11, 3, v5
    v_add_u32 v11, 1024, v11
    v_cmp_eq_u32 vcc, 4, v8
    s_nop 1
    v_cndmask_b32 v12, v10, v11, vcc
    v_add_u32 v10, 128, v10
    v_add_u32 v11, 64, v11
    v_cndmask_b32 v13, v10, v11, vcc
    v_add_u32 v12, v12, v9
    v_add_u32 v13, v13, v9
    v_cvt_pk_bf16_f32 v56, v76, v77
    v_cvt_pk_bf16_f32 v57, v78, v79
    buffer_store_dwordx2 v[56:57], v12, s[28:31], s59 offen offset:0
    v_cvt_pk_bf16_f32 v58, v92, v93
    v_cvt_pk_bf16_f32 v59, v94, v95
    buffer_store_dwordx2 v[58:59], v13, s[28:31], s59 offen offset:0
    v_cvt_pk_bf16_f32 v60, v108, v109
    v_cvt_pk_bf16_f32 v61, v110, v111
    buffer_store_dwordx2 v[60:61], v12, s[28:31], s59 offen offset:1280
    v_cvt_pk_bf16_f32 v62, v124, v125
    v_cvt_pk_bf16_f32 v63, v126, v127
    buffer_store_dwordx2 v[62:63], v13, s[28:31], s59 offen offset:1280
    v_mul_f32 v14, v76, v76
    v_fmac_f32 v14, v77, v77
    v_fmac_f32 v14, v78, v78
    v_fmac_f32 v14, v79, v79
    v_mul_f32 v15, v92, v92
    v_fmac_f32 v15, v93, v93
    v_fmac_f32 v15, v94, v94
    v_fmac_f32 v15, v95, v95
    v_mul_f32 v16, v108, v108
    v_fmac_f32 v16, v109, v109
    v_fmac_f32 v16, v110, v110
    v_fmac_f32 v16, v111, v111
    v_mul_f32 v17, v124, v124
    v_fmac_f32 v17, v125, v125
    v_fmac_f32 v17, v126, v126
    v_fmac_f32 v17, v127, v127
    v_max_f32 v14, v14, v15
    v_max3_f32 v14, v16, v17, v14
    s_nop 1
    v_max_f32_dpp v14, v14, v14 row_ror:8 row_mask:0xf bank_mask:0xf
    s_nop 1
    v_max_f32_dpp v14, v14, v14 row_ror:4 row_mask:0xf bank_mask:0xf
    s_nop 1
    v_max_f32_dpp v14, v14, v14 row_ror:2 row_mask:0xf bank_mask:0xf
    s_nop 1
    v_max_f32_dpp v14, v14, v14 row_ror:1 row_mask:0xf bank_mask:0xf
    s_lshl_b32 s60, s14, 1
    s_add_u32 s60, s60, s16
    s_lshl_b32 s60, s60, 2
    s_add_u32 s60, s60, 15749120
    v_lshlrev_b32 v15, 7, v6
    s_mov_b32 exec_lo, 0x00010001
    s_mov_b32 exec_hi, 0x00010001
    buffer_store_dword v14, v15, s[28:31], s60 offen
    s_mov_b64 exec, -1
    s_nop 0
    s_branch k1_kernel_fin
k1_kernel_fin:
k1_kernel_done:
    s_endpgm
.p2align 8
.globl k2_kernel
.type k2_kernel,@function
k2_kernel:
    s_cmp_ge_u32 s2, 256
    s_cbranch_scc1 k2_kernel_done
    s_load_dwordx2 s[4:5], s[0:1], 72
    s_and_b32 s3, s2, 7
    s_lshr_b32 s6, s2, 3
    s_lshl_b32 s12, s3, 2
    s_lshr_b32 s7, s6, 3
    s_add_u32 s12, s12, s7
    s_and_b32 s13, s6, 7
    v_lshrrev_b32 v2, 6, v0
    v_and_b32 v1, 63, v0
    s_nop 0
    v_readfirstlane_b32 s14, v2
    s_waitcnt lgkmcnt(0)
    s_mov_b32 s8, s4
    s_and_b32 s9, s5, 0xffff
    s_mov_b32 s10, 22659072
    s_mov_b32 s11, 0x00020000
    s_and_b32 s15, s14, 1
    s_lshr_b32 s16, s14, 1
    s_mov_b32 s18, 0x000fffff
    s_mov_b32 s19, 0x000fffff
    v_mov_b32 v32, 0
    v_mov_b32 v33, 0
    v_mov_b32 v34, 0
    v_mov_b32 v35, 0
    v_mov_b32 v36, 0
    v_mov_b32 v37, 0
    v_mov_b32 v38, 0
    v_mov_b32 v39, 0
    v_mov_b32 v40, 0
    v_mov_b32 v41, 0
    v_mov_b32 v42, 0
    v_mov_b32 v43, 0
    v_mov_b32 v44, 0
    v_mov_b32 v45, 0
    v_mov_b32 v46, 0
    v_mov_b32 v47, 0
    v_lshlrev_b32 v5, 4, v1
    v_lshlrev_b32 v6, 3, v1
    v_and_b32 v7, 31, v1
    v_lshrrev_b32 v8, 5, v1
    v_mul_u32_u24 v9, 320, v8
    v_lshl_add_u32 v9, v7, 4, v9
    v_cmp_gt_u32 vcc, 32, v1
    v_mov_b32 v10, 0x3f803f80
    s_nop 1
    v_cndmask_b32 v11, 0, v10, vcc
    v_cmp_eq_u32 vcc, 20, v7
    s_nop 1
    v_cndmask_b32 v12, 0, v10, vcc
    v_mov_b32 v52, 0
    v_mov_b32 v53, 0
    v_mov_b32 v54, v11
    v_mov_b32 v55, 0
    v_mov_b32 v56, v12
    v_mov_b32 v60, v12
    v_mov_b32 v208, 0
    v_mov_b32 v216, v12
    v_mov_b32 v57, v12
    v_mov_b32 v61, v12
    v_mov_b32 v209, 0
    v_mov_b32 v217, v12
    v_mov_b32 v58, v12
    v_mov_b32 v62, v12
    v_mov_b32 v210, 0
    v_mov_b32 v218, v12
    v_mov_b32 v59, v12
    v_mov_b32 v63, v12
    v_mov_b32 v211, 0
    v_mov_b32 v219, v12
    v_mov_b32 v68, 0
    v_mov_b32 v69, 0
    v_mov_b32 v70, v11
    v_mov_b32 v71, 0
    v_mov_b32 v72, v12
    v_mov_b32 v76, v12
    v_mov_b32 v212, 0
    v_mov_b32 v220, v12
    v_mov_b32 v73, v12
    v_mov_b32 v77, v12
    v_mov_b32 v213, 0
    v_mov_b32 v221, v12
    v_mov_b32 v74, v12
    v_mov_b32 v78, v12
    v_mov_b32 v214, 0
    v_mov_b32 v222, v12
    v_mov_b32 v75, v12
    v_mov_b32 v79, v12
    v_mov_b32 v215, 0
    v_mov_b32 v223, v12
    s_lshl_b32 s22, s12, 6
    s_lshl_b32 s23, s13, 3
    s_add_u32 s22, s22, s23
    s_lshl_b32 s23, s15, 2
    s_add_u32 s23, s22, s23
    s_mul_i32 s24, s23, 1280
    s_add_u32 s24, s24, 0
    buffer_load_dwordx4 v[16:19], v5, s[8:11], s24 offen offset:0
    buffer_load_dwordx4 v[20:23], v5, s[8:11], s24 offen offset:1280
    buffer_load_dwordx4 v[24:27], v5, s[8:11], s24 offen offset:2560
    buffer_load_dwordx4 v[28:31], v5, s[8:11], s24 offen offset:3840
    s_mov_b32 exec_hi, 0
    s_add_u32 s25, s24, 1024
    buffer_load_dwordx2 v[32:33], v6, s[8:11], s25 offen offset:0
    buffer_load_dwordx2 v[36:37], v6, s[8:11], s25 offen offset:1280
    buffer_load_dwordx2 v[40:41], v6, s[8:11], s25 offen offset:2560
    buffer_load_dwordx2 v[44:45], v6, s[8:11], s25 offen offset:3840
    s_mov_b32 exec_hi, -1
    v_mul_u32_u24 v13, 160*128, v8
    v_lshl_add_u32 v13, v7, 2, v13
    s_mul_i32 s26, s12, 640
    s_add_u32 s26, s26, 15728640
    buffer_load_dword v236, v13, s[8:11], s26 offen offset:0
    buffer_load_dword v237, v13, s[8:11], s26 offen offset:128
    buffer_load_dword v238, v13, s[8:11], s26 offen offset:256
    buffer_load_dword v239, v13, s[8:11], s26 offen offset:384
    buffer_load_dword v240, v13, s[8:11], s26 offen offset:512
    s_add_u32 s28, s23, s16
    s_mul_i32 s29, s28, 1280
    s_add_u32 s29, s29, 5242880
    buffer_load_dwordx4 v[224:227], v5, s[8:11], s29 offen
    v_mov_b32 v228, 0
    v_mov_b32 v229, 0
    v_mov_b32 v230, 0
    v_mov_b32 v231, 0
    s_mov_b32 exec_hi, 0
    buffer_load_dwordx2 v[228:229], v6, s[8:11], s29 offen offset:1024
    s_mov_b32 exec_hi, -1
    s_lshl_b32 s30, s15, 2
    s_add_u32 s30, s30, s16
    s_lshl_b32 s30, s30, 5
    s_lshl_b32 s31, s13, 8
    s_add_u32 s30, s30, s31
    v_add_u32 v233, s30, v7
    v_lshlrev_b32 v234, 2, v233
    s_mov_b32 s31, 15769600
    buffer_load_dword v232, v234, s[8:11], s31 offen
    s_lshl_b32 s32, s12, 6
    s_lshl_b32 s33, s16, 4
    s_add_u32 s32, s32, s33
    s_mul_i32 s36, s32, 1280
    s_add_u32 s34, s36, 2621440
    s_add_u32 s36, s36, 7864320
    s_mov_b32 s40, s34
    s_lshl_b32 s32, s12, 6
    s_lshl_b32 s33, s14, 3
    s_add_u32 s32, s32, s33
    s_mul_i32 s37, s32, 1280
    s_add_u32 s38, s37, 13107200
    s_add_u32 s37, s37, 10485760
    buffer_load_dwordx4 v[48:51], v5, s[8:11], s34 offen
    s_mov_b32 exec_hi, 0
    buffer_load_dwordx2 v[52:53], v6, s[8:11], s34 offen offset:1024
    s_mov_b32 exec_hi, -1
    s_add_u32 s34, s34, 1280
    s_mov_b64 exec, s[18:19]
    buffer_load_dwordx4 v[56:59], v9, s[8:11], s36 offen
    buffer_load_dwordx4 v[60:63], v9, s[8:11], s36 offen offset:640
    s_mov_b64 exec, -1
    s_add_u32 s36, s36, 1280
    s_mov_b64 exec, s[18:19]
    buffer_load_dwordx4 v[208:211], v9, s[8:11], s37 offen
    buffer_load_dwordx4 v[216:219], v9, s[8:11], s38 offen
    s_mov_b64 exec, -1
    s_add_u32 s37, s37, 640
    s_add_u32 s38, s38, 640
    v_mov_b32 v128, 0
    v_mov_b32 v129, 0
    v_mov_b32 v130, 0
    v_mov_b32 v131, 0
    v_mov_b32 v132, 0
    v_mov_b32 v133, 0
    v_mov_b32 v134, 0
    v_mov_b32 v135, 0
    v_mov_b32 v136, 0
    v_mov_b32 v137, 0
    v_mov_b32 v138, 0
    v_mov_b32 v139, 0
    v_mov_b32 v140, 0
    v_mov_b32 v141, 0
    v_mov_b32 v142, 0
    v_mov_b32 v143, 0
    v_mov_b32 v144, 0
    v_mov_b32 v145, 0
    v_mov_b32 v146, 0
    v_mov_b32 v147, 0
    v_mov_b32 v148, 0
    v_mov_b32 v149, 0
    v_mov_b32 v150, 0
    v_mov_b32 v151, 0
    v_mov_b32 v152, 0
    v_mov_b32 v153, 0
    v_mov_b32 v154, 0
    v_mov_b32 v155, 0
    v_mov_b32 v156, 0
    v_mov_b32 v157, 0
    v_mov_b32 v158, 0
    v_mov_b32 v159, 0
    v_mov_b32 v160, 0
    v_mov_b32 v161, 0
    v_mov_b32 v162, 0
    v_mov_b32 v163, 0
    v_mov_b32 v164, 0
    v_mov_b32 v165, 0
    v_mov_b32 v166, 0
    v_mov_b32 v167, 0
    v_mov_b32 v168, 0
    v_mov_b32 v169, 0
    v_mov_b32 v170, 0
    v_mov_b32 v171, 0
    v_mov_b32 v172, 0
    v_mov_b32 v173, 0
    v_mov_b32 v174, 0
    v_mov_b32 v175, 0
    v_mov_b32 v176, 0
    v_mov_b32 v177, 0
    v_mov_b32 v178, 0
    v_mov_b32 v179, 0
    v_mov_b32 v180, 0
    v_mov_b32 v181, 0
    v_mov_b32 v182, 0
    v_mov_b32 v183, 0
    v_mov_b32 v184, 0
    v_mov_b32 v185, 0
    v_mov_b32 v186, 0
    v_mov_b32 v187, 0
    v_mov_b32 v188, 0
    v_mov_b32 v189, 0
    v_mov_b32 v190, 0
    v_mov_b32 v191, 0
    v_mov_b32 v192, 0
    v_mov_b32 v193, 0
    v_mov_b32 v194, 0
    v_mov_b32 v195, 0
    v_mov_b32 v196, 0
    v_mov_b32 v197, 0
    v_mov_b32 v198, 0
    v_mov_b32 v199, 0
    v_mov_b32 v200, 0
    v_mov_b32 v201, 0
    v_mov_b32 v202, 0
    v_mov_b32 v203, 0
    v_mov_b32 v204, 0
    v_mov_b32 v205, 0
    v_mov_b32 v206, 0
    v_mov_b32 v207, 0
    s_waitcnt vmcnt(0)
    s_nop 1
    v_max_f32_dpp v236, v236, v236 row_ror:8 row_mask:0xf bank_mask:0xf
    v_max_f32_dpp v237, v237, v237 row_ror:8 row_mask:0xf bank_mask:0xf
    v_max_f32_dpp v238, v238, v238 row_ror:8 row_mask:0xf bank_mask:0xf
    v_max_f32_dpp v239, v239, v239 row_ror:8 row_mask:0xf bank_mask:0xf
    v_max_f32_dpp v240, v240, v240 row_ror:8 row_mask:0xf bank_mask:0xf
    s_nop 1
    v_max_f32_dpp v236, v236, v236 row_ror:4 row_mask:0xf bank_mask:0xf
    v_max_f32_dpp v237, v237, v237 row_ror:4 row_mask:0xf bank_mask:0xf
    v_max_f32_dpp v238, v238, v238 row_ror:4 row_mask:0xf bank_mask:0xf
    v_max_f32_dpp v239, v239, v239 row_ror:4 row_mask:0xf bank_mask:0xf
    v_max_f32_dpp v240, v240, v240 row_ror:4 row_mask:0xf bank_mask:0xf
    s_nop 1
    v_max_f32_dpp v236, v236, v236 row_ror:2 row_mask:0xf bank_mask:0xf
    v_max_f32_dpp v237, v237, v237 row_ror:2 row_mask:0xf bank_mask:0xf
    v_max_f32_dpp v238, v238, v238 row_ror:2 row_mask:0xf bank_mask:0xf
    v_max_f32_dpp v239, v239, v239 row_ror:2 row_mask:0xf bank_mask:0xf
    v_max_f32_dpp v240, v240, v240 row_ror:2 row_mask:0xf bank_mask:0xf
    s_nop 1
    v_max_f32_dpp v236, v236, v236 row_ror:1 row_mask:0xf bank_mask:0xf
    v_max_f32_dpp v237, v237, v237 row_ror:1 row_mask:0xf bank_mask:0xf
    v_max_f32_dpp v238, v238, v238 row_ror:1 row_mask:0xf bank_mask:0xf
    v_max_f32_dpp v239, v239, v239 row_ror:1 row_mask:0xf bank_mask:0xf
    v_max_f32_dpp v240, v240, v240 row_ror:1 row_mask:0xf bank_mask:0xf
    s_nop 0
    v_readlane_b32 s44, v236, 0
    v_readlane_b32 s45, v236, 16
    v_readlane_b32 s46, v236, 32
    v_readlane_b32 s47, v236, 48
    v_readlane_b32 s48, v237, 0
    v_readlane_b32 s49, v237, 16
    v_readlane_b32 s50, v237, 32
    v_readlane_b32 s51, v237, 48
    v_readlane_b32 s52, v238, 0
    v_readlane_b32 s53, v238, 16
    v_readlane_b32 s54, v238, 32
    v_readlane_b32 s55, v238, 48
    v_readlane_b32 s56, v239, 0
    v_readlane_b32 s57, v239, 16
    v_readlane_b32 s58, v239, 32
    v_readlane_b32 s59, v239, 48
    v_readlane_b32 s60, v240, 0
    v_readlane_b32 s61, v240, 16
    v_readlane_b32 s62, v240, 32
    v_readlane_b32 s63, v240, 48
    s_nop 2
    s_max_u32 s44, s44, s45
    s_max_u32 s46, s46, s47
    s_max_u32 s48, s48, s49
    s_max_u32 s50, s50, s51
    s_max_u32 s52, s52, s53
    s_max_u32 s54, s54, s55
    s_max_u32 s56, s56, s57
    s_max_u32 s58, s58, s59
    s_max_u32 s60, s60, s61
    s_max_u32 s62, s62, s63
    v_mov_b32 v14, s44
    v_mov_b32 v15, s46
    v_add_f32 v14, s48, v14
    v_add_f32 v15, s50, v15
    v_add_f32 v14, s52, v14
    v_add_f32 v15, s54, v15
    v_add_f32 v14, s56, v14
    v_add_f32 v15, s58, v15
    v_add_f32 v14, s60, v14
    v_add_f32 v15, s62, v15
    v_mul_f32 v14, v14, v15
    v_sqrt_f32 v14, v14
    s_nop 0
    v_mul_f32 v14, 0x3f828f5c, v14
    s_nop 0
    v_readfirstlane_b32 s42, v14
    s_nop 2
    v_mov_b32 v236, v14
    v_mov_b32 v237, v14
    v_mov_b32 v238, v14
    v_mov_b32 v239, v14
    s_cmp_gt_u32 s42, 0x42400000
    s_cbranch_scc0 k2_kernel_main
    v_mov_b32 v236, 0xff800000
    v_mov_b32 v237, 0xff800000
    v_mov_b32 v238, 0xff800000
    v_mov_b32 v239, 0xff800000
    s_mov_b32 s34, s40
    s_mov_b32 s43, 0
k2_kernel_fb:
    buffer_load_dwordx4 v[64:67], v5, s[8:11], s34 offen
    s_mov_b32 exec_hi, 0
    buffer_load_dwordx2 v[68:69], v6, s[8:11], s34 offen offset:1024
    s_mov_b32 exec_hi, -1
    s_add_u32 s34, s34, 1280
    s_waitcnt vmcnt(0)
    v_mfma_f32_32x32x16_bf16 v[80:95], v[64:67], v[16:19], 0
    v_mfma_f32_32x32x16_bf16 v[80:95], v[68:71], v[32:35], v[80:95]
    s_nop 13
    v_max3_f32 v236, v80, v81, v236
    v_max3_f32 v236, v82, v83, v236
    v_max3_f32 v236, v84, v85, v236
    v_max3_f32 v236, v86, v87, v236
    v_max3_f32 v236, v88, v89, v236
    v_max3_f32 v236, v90, v91, v236
    v_max3_f32 v236, v92, v93, v236
    v_max3_f32 v236, v94, v95, v236
    s_nop 1
    v_mfma_f32_32x32x16_bf16 v[80:95], v[64:67], v[20:23], 0
    v_mfma_f32_32x32x16_bf16 v[80:95], v[68:71], v[36:39], v[80:95]
    s_nop 13
    v_max3_f32 v237, v80, v81, v237
    v_max3_f32 v237, v82, v83, v237
    v_max3_f32 v237, v84, v85, v237
    v_max3_f32 v237, v86, v87, v237
    v_max3_f32 v237, v88, v89, v237
    v_max3_f32 v237, v90, v91, v237
    v_max3_f32 v237, v92, v93, v237
    v_max3_f32 v237, v94, v95, v237
    s_nop 1
    v_mfma_f32_32x32x16_bf16 v[80:95], v[64:67], v[24:27], 0
    v_mfma_f32_32x32x16_bf16 v[80:95], v[68:71], v[40:43], v[80:95]
    s_nop 13
    v_max3_f32 v238, v80, v81, v238
    v_max3_f32 v238, v82, v83, v238
    v_max3_f32 v238, v84, v85, v238
    v_max3_f32 v238, v86, v87, v238
    v_max3_f32 v238, v88, v89, v238
    v_max3_f32 v238, v90, v91, v238
    v_max3_f32 v238, v92, v93, v238
    v_max3_f32 v238, v94, v95, v238
    s_nop 1
    v_mfma_f32_32x32x16_bf16 v[80:95], v[64:67], v[28:31], 0
    v_mfma_f32_32x32x16_bf16 v[80:95], v[68:71], v[44:47], v[80:95]
    s_nop 13
    v_max3_f32 v239, v80, v81, v239
    v_max3_f32 v239, v82, v83, v239
    v_max3_f32 v239, v84, v85, v239
    v_max3_f32 v239, v86, v87, v239
    v_max3_f32 v239, v88, v89, v239
    v_max3_f32 v239, v90, v91, v239
    v_max3_f32 v239, v92, v93, v239
    v_max3_f32 v239, v94, v95, v239
    s_nop 1
    s_add_u32 s43, s43, 1
    s_cmp_lt_u32 s43, 16
    s_cbranch_scc1 k2_kernel_fb
    v_mov_b32 v2, v236
    v_mov_b32 v3, v236
    s_nop 1
    v_permlane32_swap_b32 v2, v3
    s_nop 1
    v_max_f32 v236, v2, v3
    v_mov_b32 v2, v237
    v_mov_b32 v3, v237
    s_nop 1
    v_permlane32_swap_b32 v2, v3
    s_nop 1
    v_max_f32 v237, v2, v3
    v_mov_b32 v2, v238
    v_mov_b32 v3, v238
    s_nop 1
    v_permlane32_swap_b32 v2, v3
    s_nop 1
    v_max_f32 v238, v2, v3
    v_mov_b32 v2, v239
    v_mov_b32 v3, v239
    s_nop 1
    v_permlane32_swap_b32 v2, v3
    s_nop 1
    v_max_f32 v239, v2, v3
    s_lshl_b32 s44, s14, 10
    v_lshlrev_b32 v2, 2, v1
    v_add_u32 v3, s44, v2
    ds_write_b32 v3, v236 offset:0
    ds_write_b32 v3, v237 offset:256
    ds_write_b32 v3, v238 offset:512
    ds_write_b32 v3, v239 offset:768
    s_waitcnt lgkmcnt(0)
    s_barrier
    s_lshl_b32 s44, s15, 10
    v_add_u32 v3, s44, v2
    ds_read_b32 v240, v3 offset:0
    ds_read_b32 v241, v3 offset:2048
    ds_read_b32 v242, v3 offset:4096
    ds_read_b32 v243, v3 offset:6144
    s_waitcnt lgkmcnt(0)
    v_max3_f32 v236, v240, v241, v242
    v_max_f32 v236, v236, v243
    ds_read_b32 v240, v3 offset:256
    ds_read_b32 v241, v3 offset:2304
    ds_read_b32 v242, v3 offset:4352
    ds_read_b32 v243, v3 offset:6400
    s_waitcnt lgkmcnt(0)
    v_max3_f32 v237, v240, v241, v242
    v_max_f32 v237, v237, v243
    ds_read_b32 v240, v3 offset:512
    ds_read_b32 v241, v3 offset:2560
    ds_read_b32 v242, v3 offset:4608
    ds_read_b32 v243, v3 offset:6656
    s_waitcnt lgkmcnt(0)
    v_max3_f32 v238, v240, v241, v242
    v_max_f32 v238, v238, v243
    ds_read_b32 v240, v3 offset:768
    ds_read_b32 v241, v3 offset:2816
    ds_read_b32 v242, v3 offset:4864
    ds_read_b32 v243, v3 offset:6912
    s_waitcnt lgkmcnt(0)
    v_max3_f32 v239, v240, v241, v242
    v_max_f32 v239, v239, v243
    s_mov_b32 s34, s40
    buffer_load_dwordx4 v[48:51], v5, s[8:11], s34 offen
    s_mov_b32 exec_hi, 0
    buffer_load_dwordx2 v[52:53], v6, s[8:11], s34 offen offset:1024
    s_mov_b32 exec_hi, -1
    s_add_u32 s34, s34, 1280
    s_waitcnt vmcnt(0)
k2_kernel_main:
    s_mov_b32 exec_hi, 0
    v_sub_f32 v2, 0, v236
    v_cvt_pk_bf16_f32 v3, v2, v2
    v_lshlrev_b32 v3, 16, v3
    v_sub_f32 v4, v2, v3
    v_cvt_pk_bf16_f32 v34, v2, v4
    v_sub_f32 v2, 0, v237
    v_cvt_pk_bf16_f32 v3, v2, v2
    v_lshlrev_b32 v3, 16, v3
    v_sub_f32 v4, v2, v3
    v_cvt_pk_bf16_f32 v38, v2, v4
    v_sub_f32 v2, 0, v238
    v_cvt_pk_bf16_f32 v3, v2, v2
    v_lshlrev_b32 v3, 16, v3
    v_sub_f32 v4, v2, v3
    v_cvt_pk_bf16_f32 v42, v2, v4
    v_sub_f32 v2, 0, v239
    v_cvt_pk_bf16_f32 v3, v2, v2
    v_lshlrev_b32 v3, 16, v3
    v_sub_f32 v4, v2, v3
    v_cvt_pk_bf16_f32 v46, v2, v4
    s_mov_b32 exec_hi, -1
    s_nop 1
    v_mfma_f32_32x32x16_bf16 v[80:95], v[48:51], v[16:19], 0
    v_mfma_f32_32x32x16_bf16 v[80:95], v[52:55], v[32:35], v[80:95]
    s_nop 15
    s_mov_b32 s43, 0
    v_mov_b32 v120, 0
    v_mov_b32 v121, 0
    v_mov_b32 v122, 0
    v_mov_b32 v123, 0
    v_mov_b32 v124, 0
    v_mov_b32 v125, 0
    v_mov_b32 v126, 0
    v_mov_b32 v127, 0
    s_nop 1
    s_cmp_ge_u32 s14, 4
    s_cbranch_scc0 k2p_5
    s_setprio 1
k2p_5:
k2_kernel_loop:
    v_mfma_f32_32x32x16_bf16 v[96:111], v[48:51], v[20:23], 0
    buffer_load_dwordx4 v[64:67], v5, s[8:11], s34 offen
    s_mov_b32 exec_hi, 0
    buffer_load_dwordx2 v[68:69], v6, s[8:11], s34 offen offset:1024
    s_mov_b32 exec_hi, -1
    s_add_u32 s34, s34, 1280
    v_exp_f32 v80, v80
    v_exp_f32 v81, v81
    v_exp_f32 v82, v82
    v_exp_f32 v83, v83
    v_cvt_pk_bf16_f32 v112, v80, v81
    v_cvt_pk_bf16_f32 v113, v82, v83
    v_mfma_f32_32x32x16_bf16 v[96:111], v[52:55], v[36:39], v[96:111]
    v_exp_f32 v84, v84
    v_exp_f32 v85, v85
    v_exp_f32 v86, v86
    v_exp_f32 v87, v87
    v_cvt_pk_bf16_f32 v114, v84, v85
    v_cvt_pk_bf16_f32 v115, v86, v87
    v_mfma_f32_32x32x16_bf16 v[176:191], v[76:79], v[124:127], v[176:191]
    v_exp_f32 v88, v88
    v_exp_f32 v89, v89
    v_exp_f32 v90, v90
    v_exp_f32 v91, v91
    v_cvt_pk_bf16_f32 v116, v88, v89
    v_cvt_pk_bf16_f32 v117, v90, v91
    s_waitcnt vmcnt(4)
    v_mfma_f32_32x32x16_bf16 v[128:143], v[56:59], v[112:115], v[128:143]
    v_exp_f32 v92, v92
    v_exp_f32 v93, v93
    v_exp_f32 v94, v94
    v_exp_f32 v95, v95
    v_cvt_pk_bf16_f32 v118, v92, v93
    v_cvt_pk_bf16_f32 v119, v94, v95
    v_mfma_f32_32x32x16_bf16 v[80:95], v[48:51], v[24:27], 0
    v_exp_f32 v96, v96
    v_exp_f32 v97, v97
    v_exp_f32 v98, v98
    v_exp_f32 v99, v99
    v_cvt_pk_bf16_f32 v120, v96, v97
    v_cvt_pk_bf16_f32 v121, v98, v99
    v_mfma_f32_32x32x16_bf16 v[80:95], v[52:55], v[40:43], v[80:95]
    v_exp_f32 v100, v100
    v_exp_f32 v101, v101
    v_exp_f32 v102, v102
    v_exp_f32 v103, v103
    v_cvt_pk_bf16_f32 v122, v100, v101
    v_cvt_pk_bf16_f32 v123, v102, v103
    v_mfma_f32_32x32x16_bf16 v[128:143], v[60:63], v[116:119], v[128:143]
    s_waitcnt vmcnt(2)
    v_mfma_f32_32x32x16_bf16 v[192:207], v[208:211], v[216:219], v[192:207]
    s_mov_b64 exec, s[18:19]
    buffer_load_dwordx4 v[72:75], v9, s[8:11], s36 offen
    buffer_load_dwordx4 v[76:79], v9, s[8:11], s36 offen offset:640
    s_mov_b64 exec, -1
    s_add_u32 s36, s36, 1280
    v_exp_f32 v104, v104
    v_exp_f32 v105, v105
    v_exp_f32 v106, v106
    v_exp_f32 v107, v107
    v_cvt_pk_bf16_f32 v124, v104, v105
    v_cvt_pk_bf16_f32 v125, v106, v107
    v_mfma_f32_32x32x16_bf16 v[144:159], v[56:59], v[120:123], v[144:159]
    v_exp_f32 v108, v108
    v_exp_f32 v109, v109
    v_exp_f32 v110, v110
    v_exp_f32 v111, v111
    v_cvt_pk_bf16_f32 v126, v108, v109
    v_cvt_pk_bf16_f32 v127, v110, v111
    v_mfma_f32_32x32x16_bf16 v[96:111], v[48:51], v[28:31], 0
    v_exp_f32 v80, v80
    v_exp_f32 v81, v81
    v_exp_f32 v82, v82
    v_exp_f32 v83, v83
    v_cvt_pk_bf16_f32 v112, v80, v81
    v_cvt_pk_bf16_f32 v113, v82, v83
    v_mfma_f32_32x32x16_bf16 v[96:111], v[52:55], v[44:47], v[96:111]
    v_exp_f32 v84, v84
    v_exp_f32 v85, v85
    v_exp_f32 v86, v86
    v_exp_f32 v87, v87
    v_cvt_pk_bf16_f32 v114, v84, v85
    v_cvt_pk_bf16_f32 v115, v86, v87
    v_mfma_f32_32x32x16_bf16 v[144:159], v[60:63], v[124:127], v[144:159]
    s_mov_b64 exec, s[18:19]
    buffer_load_dwordx4 v[212:215], v9, s[8:11], s37 offen
    buffer_load_dwordx4 v[220:223], v9, s[8:11], s38 offen
    s_mov_b64 exec, -1
    s_add_u32 s37, s37, 640
    s_add_u32 s38, s38, 640
    v_exp_f32 v88, v88
    v_exp_f32 v89, v89
    v_exp_f32 v90, v90
    v_exp_f32 v91, v91
    v_cvt_pk_bf16_f32 v116, v88, v89
    v_cvt_pk_bf16_f32 v117, v90, v91
    v_mfma_f32_32x32x16_bf16 v[160:175], v[56:59], v[112:115], v[160:175]
    v_exp_f32 v92, v92
    v_exp_f32 v93, v93
    v_exp_f32 v94, v94
    v_exp_f32 v95, v95
    v_cvt_pk_bf16_f32 v118, v92, v93
    v_cvt_pk_bf16_f32 v119, v94, v95
    s_waitcnt vmcnt(4)
    v_mfma_f32_32x32x16_bf16 v[80:95], v[64:67], v[16:19], 0
    v_exp_f32 v96, v96
    v_exp_f32 v97, v97
    v_exp_f32 v98, v98
    v_exp_f32 v99, v99
    v_cvt_pk_bf16_f32 v120, v96, v97
    v_cvt_pk_bf16_f32 v121, v98, v99
    v_mfma_f32_32x32x16_bf16 v[80:95], v[68:71], v[32:35], v[80:95]
    v_exp_f32 v100, v100
    v_exp_f32 v101, v101
    v_exp_f32 v102, v102
    v_exp_f32 v103, v103
    v_cvt_pk_bf16_f32 v122, v100, v101
    v_cvt_pk_bf16_f32 v123, v102, v103
    v_mfma_f32_32x32x16_bf16 v[160:175], v[60:63], v[116:119], v[160:175]
    v_exp_f32 v104, v104
    v_exp_f32 v105, v105
    v_exp_f32 v106, v106
    v_exp_f32 v107, v107
    v_cvt_pk_bf16_f32 v124, v104, v105
    v_cvt_pk_bf16_f32 v125, v106, v107
    v_mfma_f32_32x32x16_bf16 v[176:191], v[56:59], v[120:123], v[176:191]
    v_exp_f32 v108, v108
    v_exp_f32 v109, v109
    v_exp_f32 v110, v110
    v_exp_f32 v111, v111
    v_cvt_pk_bf16_f32 v126, v108, v109
    v_cvt_pk_bf16_f32 v127, v110, v111
    v_mfma_f32_32x32x16_bf16 v[96:111], v[64:67], v[20:23], 0
    buffer_load_dwordx4 v[48:51], v5, s[8:11], s34 offen
    s_mov_b32 exec_hi, 0
    buffer_load_dwordx2 v[52:53], v6, s[8:11], s34 offen offset:1024
    s_mov_b32 exec_hi, -1
    s_add_u32 s34, s34, 1280
    v_exp_f32 v80, v80
    v_exp_f32 v81, v81
    v_exp_f32 v82, v82
    v_exp_f32 v83, v83
    v_cvt_pk_bf16_f32 v112, v80, v81
    v_cvt_pk_bf16_f32 v113, v82, v83
    v_mfma_f32_32x32x16_bf16 v[96:111], v[68:71], v[36:39], v[96:111]
    v_exp_f32 v84, v84
    v_exp_f32 v85, v85
    v_exp_f32 v86, v86
    v_exp_f32 v87, v87
    v_cvt_pk_bf16_f32 v114, v84, v85
    v_cvt_pk_bf16_f32 v115, v86, v87
    v_mfma_f32_32x32x16_bf16 v[176:191], v[60:63], v[124:127], v[176:191]
    v_exp_f32 v88, v88
    v_exp_f32 v89, v89
    v_exp_f32 v90, v90
    v_exp_f32 v91, v91
    v_cvt_pk_bf16_f32 v116, v88, v89
    v_cvt_pk_bf16_f32 v117, v90, v91
    s_waitcnt vmcnt(4)
    v_mfma_f32_32x32x16_bf16 v[128:143], v[72:75], v[112:115], v[128:143]
    v_exp_f32 v92, v92
    v_exp_f32 v93, v93
    v_exp_f32 v94, v94
    v_exp_f32 v95, v95
    v_cvt_pk_bf16_f32 v118, v92, v93
    v_cvt_pk_bf16_f32 v119, v94, v95
    v_mfma_f32_32x32x16_bf16 v[80:95], v[64:67], v[24:27], 0
    v_exp_f32 v96, v96
    v_exp_f32 v97, v97
    v_exp_f32 v98, v98
    v_exp_f32 v99, v99
    v_cvt_pk_bf16_f32 v120, v96, v97
    v_cvt_pk_bf16_f32 v121, v98, v99
    v_mfma_f32_32x32x16_bf16 v[80:95], v[68:71], v[40:43], v[80:95]
    v_exp_f32 v100, v100
    v_exp_f32 v101, v101
    v_exp_f32 v102, v102
    v_exp_f32 v103, v103
    v_cvt_pk_bf16_f32 v122, v100, v101
    v_cvt_pk_bf16_f32 v123, v102, v103
    v_mfma_f32_32x32x16_bf16 v[128:143], v[76:79], v[116:119], v[128:143]
    s_waitcnt vmcnt(2)
    v_mfma_f32_32x32x16_bf16 v[192:207], v[212:215], v[220:223], v[192:207]
    s_mov_b64 exec, s[18:19]
    buffer_load_dwordx4 v[56:59], v9, s[8:11], s36 offen
    buffer_load_dwordx4 v[60:63], v9, s[8:11], s36 offen offset:640
    s_mov_b64 exec, -1
    s_add_u32 s36, s36, 1280
    v_exp_f32 v104, v104
    v_exp_f32 v105, v105
    v_exp_f32 v106, v106
    v_exp_f32 v107, v107
    v_cvt_pk_bf16_f32 v124, v104, v105
    v_cvt_pk_bf16_f32 v125, v106, v107
    v_mfma_f32_32x32x16_bf16 v[144:159], v[72:75], v[120:123], v[144:159]
    v_exp_f32 v108, v108
    v_exp_f32 v109, v109
    v_exp_f32 v110, v110
    v_exp_f32 v111, v111
    v_cvt_pk_bf16_f32 v126, v108, v109
    v_cvt_pk_bf16_f32 v127, v110, v111
    v_mfma_f32_32x32x16_bf16 v[96:111], v[64:67], v[28:31], 0
    v_exp_f32 v80, v80
    v_exp_f32 v81, v81
    v_exp_f32 v82, v82
    v_exp_f32 v83, v83
    v_cvt_pk_bf16_f32 v112, v80, v81
    v_cvt_pk_bf16_f32 v113, v82, v83
    v_mfma_f32_32x32x16_bf16 v[96:111], v[68:71], v[44:47], v[96:111]
    v_exp_f32 v84, v84
    v_exp_f32 v85, v85
    v_exp_f32 v86, v86
    v_exp_f32 v87, v87
    v_cvt_pk_bf16_f32 v114, v84, v85
    v_cvt_pk_bf16_f32 v115, v86, v87
    v_mfma_f32_32x32x16_bf16 v[144:159], v[76:79], v[124:127], v[144:159]
    s_mov_b64 exec, s[18:19]
    buffer_load_dwordx4 v[208:211], v9, s[8:11], s37 offen
    buffer_load_dwordx4 v[216:219], v9, s[8:11], s38 offen
    s_mov_b64 exec, -1
    s_add_u32 s37, s37, 640
    s_add_u32 s38, s38, 640
    v_exp_f32 v88, v88
    v_exp_f32 v89, v89
    v_exp_f32 v90, v90
    v_exp_f32 v91, v91
    v_cvt_pk_bf16_f32 v116, v88, v89
    v_cvt_pk_bf16_f32 v117, v90, v91
    v_mfma_f32_32x32x16_bf16 v[160:175], v[72:75], v[112:115], v[160:175]
    v_exp_f32 v92, v92
    v_exp_f32 v93, v93
    v_exp_f32 v94, v94
    v_exp_f32 v95, v95
    v_cvt_pk_bf16_f32 v118, v92, v93
    v_cvt_pk_bf16_f32 v119, v94, v95
    s_waitcnt vmcnt(4)
    v_mfma_f32_32x32x16_bf16 v[80:95], v[48:51], v[16:19], 0
    v_exp_f32 v96, v96
    v_exp_f32 v97, v97
    v_exp_f32 v98, v98
    v_exp_f32 v99, v99
    v_cvt_pk_bf16_f32 v120, v96, v97
    v_cvt_pk_bf16_f32 v121, v98, v99
    v_mfma_f32_32x32x16_bf16 v[80:95], v[52:55], v[32:35], v[80:95]
    v_exp_f32 v100, v100
    v_exp_f32 v101, v101
    v_exp_f32 v102, v102
    v_exp_f32 v103, v103
    v_cvt_pk_bf16_f32 v122, v100, v101
    v_cvt_pk_bf16_f32 v123, v102, v103
    v_mfma_f32_32x32x16_bf16 v[160:175], v[76:79], v[116:119], v[160:175]
    v_exp_f32 v104, v104
    v_exp_f32 v105, v105
    v_exp_f32 v106, v106
    v_exp_f32 v107, v107
    v_cvt_pk_bf16_f32 v124, v104, v105
    v_cvt_pk_bf16_f32 v125, v106, v107
    v_mfma_f32_32x32x16_bf16 v[176:191], v[72:75], v[120:123], v[176:191]
    v_exp_f32 v108, v108
    v_exp_f32 v109, v109
    v_exp_f32 v110, v110
    v_exp_f32 v111, v111
    v_cvt_pk_bf16_f32 v126, v108, v109
    v_cvt_pk_bf16_f32 v127, v110, v111
    s_add_u32 s43, s43, 1
    s_cmp_lt_u32 s43, 8
    s_cbranch_scc1 k2_kernel_loop
    s_nop 1
    v_mfma_f32_32x32x16_bf16 v[176:191], v[76:79], v[124:127], v[176:191]
    s_nop 15
    s_waitcnt vmcnt(0)
    s_lshl_b32 s44, s15, 2
    s_add_u32 s44, s44, s16
    s_add_u32 s44, s44, 0
    s_mul_i32 s44, s44, 3072
    s_add_u32 s44, s44, 32768
    v_add_u32 v2, s44, v5
    ds_write_b128 v2, v[128:131] offset:0
    ds_write_b128 v2, v[132:135] offset:1024
    ds_write_b128 v2, v[136:139] offset:2048
    s_lshl_b32 s44, s15, 2
    s_add_u32 s44, s44, s16
    s_add_u32 s44, s44, 8
    s_mul_i32 s44, s44, 3072
    s_add_u32 s44, s44, 32768
    v_add_u32 v2, s44, v5
    ds_write_b128 v2, v[144:147] offset:0
    ds_write_b128 v2, v[148:151] offset:1024
    ds_write_b128 v2, v[152:155] offset:2048
    s_lshl_b32 s44, s15, 2
    s_add_u32 s44, s44, s16
    s_add_u32 s44, s44, 16
    s_mul_i32 s44, s44, 3072
    s_add_u32 s44, s44, 32768
    v_add_u32 v2, s44, v5
    ds_write_b128 v2, v[160:163] offset:0
    ds_write_b128 v2, v[164:167] offset:1024
    ds_write_b128 v2, v[168:171] offset:2048
    s_lshl_b32 s44, s15, 2
    s_add_u32 s44, s44, s16
    s_add_u32 s44, s44, 24
    s_mul_i32 s44, s44, 3072
    s_add_u32 s44, s44, 32768
    v_add_u32 v2, s44, v5
    ds_write_b128 v2, v[176:179] offset:0
    ds_write_b128 v2, v[180:183] offset:1024
    ds_write_b128 v2, v[184:187] offset:2048
    s_mul_i32 s44, s14, 3072
    v_add_u32 v2, s44, v5
    ds_write_b128 v2, v[192:195] offset:8192
    ds_write_b128 v2, v[196:199] offset:9216
    ds_write_b128 v2, v[200:203] offset:10240
    s_waitcnt lgkmcnt(0)
    s_barrier
    s_mul_i32 s44, s14, 12288
    s_add_u32 s44, s44, 32768
    v_add_u32 v2, s44, v5
    ds_read_b128 v[128:131], v2 offset:0
    ds_read_b128 v[132:135], v2 offset:1024
    ds_read_b128 v[136:139], v2 offset:2048
    ds_read_b128 v[140:143], v2 offset:3072
    ds_read_b128 v[144:147], v2 offset:4096
    ds_read_b128 v[148:151], v2 offset:5120
    ds_read_b128 v[152:155], v2 offset:6144
    ds_read_b128 v[156:159], v2 offset:7168
    ds_read_b128 v[160:163], v2 offset:8192
    ds_read_b128 v[164:167], v2 offset:9216
    ds_read_b128 v[168:171], v2 offset:10240
    ds_read_b128 v[172:175], v2 offset:11264
    ds_read_b128 v[16:19], v5 offset:8192
    ds_read_b128 v[20:23], v5 offset:9216
    ds_read_b128 v[24:27], v5 offset:10240
    ds_read_b128 v[28:31], v5 offset:11264
    ds_read_b128 v[32:35], v5 offset:12288
    ds_read_b128 v[36:39], v5 offset:13312
    ds_read_b128 v[40:43], v5 offset:14336
    ds_read_b128 v[44:47], v5 offset:15360
    ds_read_b128 v[48:51], v5 offset:16384
    ds_read_b128 v[52:55], v5 offset:17408
    ds_read_b128 v[56:59], v5 offset:18432
    ds_read_b128 v[60:63], v5 offset:19456
    ds_read_b128 v[64:67], v5 offset:20480
    ds_read_b128 v[68:71], v5 offset:21504
    ds_read_b128 v[72:75], v5 offset:22528
    ds_read_b128 v[76:79], v5 offset:23552
    ds_read_b128 v[80:83], v5 offset:24576
    ds_read_b128 v[84:87], v5 offset:25600
    ds_read_b128 v[88:91], v5 offset:26624
    ds_read_b128 v[92:95], v5 offset:27648
    ds_read_b128 v[96:99], v5 offset:28672
    ds_read_b128 v[100:103], v5 offset:29696
    ds_read_b128 v[104:107], v5 offset:30720
    ds_read_b128 v[108:111], v5 offset:31744
    s_waitcnt lgkmcnt(0)
    v_add_f32 v16, v16, v64
    v_add_f32 v17, v17, v65
    v_add_f32 v18, v18, v66
    v_add_f32 v19, v19, v67
    v_add_f32 v20, v20, v68
    v_add_f32 v21, v21, v69
    v_add_f32 v22, v22, v70
    v_add_f32 v23, v23, v71
    v_add_f32 v24, v24, v72
    v_add_f32 v25, v25, v73
    v_add_f32 v26, v26, v74
    v_add_f32 v27, v27, v75
    v_add_f32 v28, v28, v76
    v_add_f32 v29, v29, v77
    v_add_f32 v30, v30, v78
    v_add_f32 v31, v31, v79
    v_add_f32 v32, v32, v80
    v_add_f32 v33, v33, v81
    v_add_f32 v34, v34, v82
    v_add_f32 v35, v35, v83
    v_add_f32 v36, v36, v84
    v_add_f32 v37, v37, v85
    v_add_f32 v38, v38, v86
    v_add_f32 v39, v39, v87
    v_add_f32 v40, v40, v88
    v_add_f32 v41, v41, v89
    v_add_f32 v42, v42, v90
    v_add_f32 v43, v43, v91
    v_add_f32 v44, v44, v92
    v_add_f32 v45, v45, v93
    v_add_f32 v46, v46, v94
    v_add_f32 v47, v47, v95
    v_add_f32 v48, v48, v96
    v_add_f32 v49, v49, v97
    v_add_f32 v50, v50, v98
    v_add_f32 v51, v51, v99
    v_add_f32 v52, v52, v100
    v_add_f32 v53, v53, v101
    v_add_f32 v54, v54, v102
    v_add_f32 v55, v55, v103
    v_add_f32 v56, v56, v104
    v_add_f32 v57, v57, v105
    v_add_f32 v58, v58, v106
    v_add_f32 v59, v59, v107
    v_add_f32 v60, v60, v108
    v_add_f32 v61, v61, v109
    v_add_f32 v62, v62, v110
    v_add_f32 v63, v63, v111
    v_add_f32 v16, v16, v40
    v_add_f32 v17, v17, v41
    v_add_f32 v18, v18, v42
    v_add_f32 v19, v19, v43
    v_add_f32 v20, v20, v44
    v_add_f32 v21, v21, v45
    v_add_f32 v22, v22, v46
    v_add_f32 v23, v23, v47
    v_add_f32 v24, v24, v48
    v_add_f32 v25, v25, v49
    v_add_f32 v26, v26, v50
    v_add_f32 v27, v27, v51
    v_add_f32 v28, v28, v52
    v_add_f32 v29, v29, v53
    v_add_f32 v30, v30, v54
    v_add_f32 v31, v31, v55
    v_add_f32 v32, v32, v56
    v_add_f32 v33, v33, v57
    v_add_f32 v34, v34, v58
    v_add_f32 v35, v35, v59
    v_add_f32 v36, v36, v60
    v_add_f32 v37, v37, v61
    v_add_f32 v38, v38, v62
    v_add_f32 v39, v39, v63
    v_add_f32 v16, v16, v28
    v_add_f32 v17, v17, v29
    v_add_f32 v18, v18, v30
    v_add_f32 v19, v19, v31
    v_add_f32 v20, v20, v32
    v_add_f32 v21, v21, v33
    v_add_f32 v22, v22, v34
    v_add_f32 v23, v23, v35
    v_add_f32 v24, v24, v36
    v_add_f32 v25, v25, v37
    v_add_f32 v26, v26, v38
    v_add_f32 v27, v27, v39
    v_cvt_pk_bf16_f32 v48, v16, v17
    v_cvt_pk_bf16_f32 v49, v18, v19
    v_cvt_pk_bf16_f32 v50, v20, v21
    v_cvt_pk_bf16_f32 v51, v22, v23
    v_cvt_pk_bf16_f32 v52, v24, v25
    v_cvt_pk_bf16_f32 v53, v26, v27
    v_mov_b32 v54, 0
    v_mov_b32 v55, 0
    s_nop 1
    v_mfma_f32_32x32x16_bf16 v[80:95], v[48:51], v[224:227], 0
    v_mfma_f32_32x32x16_bf16 v[80:95], v[52:55], v[228:231], v[80:95]
    v_add_f32 v128, v128, v140
    v_add_f32 v152, v152, v164
    v_add_f32 v129, v129, v141
    v_add_f32 v153, v153, v165
    v_add_f32 v130, v130, v142
    v_add_f32 v154, v154, v166
    v_add_f32 v131, v131, v143
    v_add_f32 v155, v155, v167
    v_add_f32 v132, v132, v144
    v_add_f32 v156, v156, v168
    v_add_f32 v133, v133, v145
    v_add_f32 v157, v157, v169
    v_add_f32 v134, v134, v146
    v_add_f32 v158, v158, v170
    v_add_f32 v135, v135, v147
    v_add_f32 v159, v159, v171
    v_add_f32 v136, v136, v148
    v_add_f32 v160, v160, v172
    v_add_f32 v137, v137, v149
    v_add_f32 v161, v161, v173
    v_add_f32 v138, v138, v150
    v_add_f32 v162, v162, v174
    v_add_f32 v139, v139, v151
    v_add_f32 v163, v163, v175
    v_add_f32 v128, v128, v152
    v_add_f32 v129, v129, v153
    v_add_f32 v130, v130, v154
    v_add_f32 v131, v131, v155
    v_add_f32 v132, v132, v156
    v_add_f32 v133, v133, v157
    v_add_f32 v134, v134, v158
    v_add_f32 v135, v135, v159
    v_add_f32 v136, v136, v160
    v_add_f32 v137, v137, v161
    v_add_f32 v138, v138, v162
    v_add_f32 v139, v139, v163
    v_lshrrev_b32 v4, 4, v233
    v_mul_u32_u24 v4, 40960, v4
    v_and_b32 v10, 15, v233
    v_lshl_add_u32 v4, v10, 4, v4
    s_mul_i32 s44, s12, 1280
    s_add_u32 s45, s44, 15777792
    v_lshl_add_u32 v4, v8, 8, v4
    v_mov_b32 v2, v136
    v_mov_b32 v3, v136
    s_nop 1
    v_permlane32_swap_b32 v2, v3
    s_nop 1
    v_rcp_f32 v3, v3
    v_sub_f32 v2, 1.0, v232
    v_mul_f32 v3, v3, v2
    v_mul_f32 v128, v128, v3
    v_mul_f32 v129, v129, v3
    v_mul_f32 v130, v130, v3
    v_mul_f32 v131, v131, v3
    v_mul_f32 v132, v132, v3
    v_mul_f32 v133, v133, v3
    v_mul_f32 v134, v134, v3
    v_mul_f32 v135, v135, v3
    v_mul_f32 v136, v136, v3
    v_mul_f32 v137, v137, v3
    v_mul_f32 v138, v138, v3
    v_mul_f32 v139, v139, v3
    v_cvt_pk_bf16_f32 v200, v128, v129
    v_cvt_pk_bf16_f32 v201, v130, v131
    v_cvt_pk_bf16_f32 v202, v132, v133
    v_cvt_pk_bf16_f32 v203, v134, v135
    v_cvt_pk_bf16_f32 v208, v136, v137
    v_cvt_pk_bf16_f32 v209, v138, v139
    s_nop 3
    v_mov_b32 v2, v88
    v_mov_b32 v3, v88
    s_nop 1
    v_permlane32_swap_b32 v2, v3
    s_nop 1
    v_add_f32 v3, 0x358637bd, v3
    v_rcp_f32 v3, v3
    v_mov_b32 v2, v232
    v_mul_f32 v3, v3, v2
    v_mul_f32 v80, v80, v3
    v_mul_f32 v81, v81, v3
    v_mul_f32 v82, v82, v3
    v_mul_f32 v83, v83, v3
    v_mul_f32 v84, v84, v3
    v_mul_f32 v85, v85, v3
    v_mul_f32 v86, v86, v3
    v_mul_f32 v87, v87, v3
    v_mul_f32 v88, v88, v3
    v_mul_f32 v89, v89, v3
    v_mul_f32 v90, v90, v3
    v_mul_f32 v91, v91, v3
    v_cvt_pk_bf16_f32 v204, v80, v81
    v_cvt_pk_bf16_f32 v205, v82, v83
    v_cvt_pk_bf16_f32 v206, v84, v85
    v_cvt_pk_bf16_f32 v207, v86, v87
    v_cvt_pk_bf16_f32 v210, v88, v89
    v_cvt_pk_bf16_f32 v211, v90, v91
    buffer_store_dwordx4 v[200:203], v4, s[8:11], s45 offen
    buffer_store_dwordx4 v[204:207], v4, s[8:11], s45 offen offset:512
    s_mov_b32 exec_hi, 0
    buffer_store_dwordx4 v[208:211], v4, s[8:11], s45 offen offset:1024
    s_mov_b32 exec_hi, -1
k2_kernel_fin:
k2_kernel_done:
    s_endpgm
.p2align 8
.globl k3_kernel
.type k3_kernel,@function
k3_kernel:
    s_cmp_ge_u32 s2, 256
    s_cbranch_scc1 k3_kernel_done
    s_load_dwordx2 s[8:9], s[0:1], 56
    s_load_dwordx2 s[12:13], s[0:1], 72
    s_and_b32 s3, s2, 7
    s_lshr_b32 s14, s2, 3
    s_lshl_b32 s15, s3, 2
    s_lshr_b32 s16, s14, 3
    s_add_u32 s15, s15, s16
    s_and_b32 s16, s14, 7
    v_lshrrev_b32 v2, 6, v0
    v_and_b32 v1, 63, v0
    s_nop 0
    v_readfirstlane_b32 s17, v2
    s_waitcnt lgkmcnt(0)
    s_mov_b32 s24, s12
    s_and_b32 s25, s13, 0xffff
    s_mov_b32 s26, 22659072
    s_mov_b32 s27, 0x00020000
    s_mov_b32 s28, s8
    s_and_b32 s29, s9, 0xffff
    s_mov_b32 s30, 2621440
    s_mov_b32 s31, 0x00020000
    v_and_b32 v2, 15, v1
    v_lshrrev_b32 v3, 4, v1
    v_lshlrev_b32 v4, 4, v1
    s_mul_i32 s33, s15, 160
    s_mul_i32 s34, s17, 10
    s_add_u32 s33, s33, s34
    s_lshl_b32 s33, s33, 10
    s_add_u32 s33, s33, 15777792
    s_add_u32 s36, s33, 0
    s_add_u32 s37, s33, 40960
    s_add_u32 s38, s33, 81920
    s_add_u32 s39, s33, 122880
    s_mul_i32 s40, s16, 40
    s_add_u32 s40, s40, s34
    s_mul_i32 s40, s40, 5120
    s_add_u32 s40, s40, 21020672
    buffer_load_dwordx4 a[0:3], v4, s[24:27], s40 offen offset:0
    buffer_load_dwordx4 a[4:7], v4, s[24:27], s40 offen offset:1024
    buffer_load_dwordx4 a[8:11], v4, s[24:27], s40 offen offset:2048
    buffer_load_dwordx4 a[12:15], v4, s[24:27], s40 offen offset:3072
    s_add_u32 s41, s40, 4096
    buffer_load_dwordx4 a[16:19], v4, s[24:27], s41 offen
    s_add_u32 s40, s40, 5120
    buffer_load_dwordx4 a[20:23], v4, s[24:27], s36 offen offset:0
    buffer_load_dwordx4 a[24:27], v4, s[24:27], s37 offen offset:0
    buffer_load_dwordx4 a[28:31], v4, s[24:27], s38 offen offset:0
    buffer_load_dwordx4 a[32:35], v4, s[24:27], s39 offen offset:0
    buffer_load_dwordx4 a[36:39], v4, s[24:27], s40 offen offset:0
    buffer_load_dwordx4 a[40:43], v4, s[24:27], s40 offen offset:1024
    buffer_load_dwordx4 a[44:47], v4, s[24:27], s40 offen offset:2048
    buffer_load_dwordx4 a[48:51], v4, s[24:27], s40 offen offset:3072
    s_add_u32 s41, s40, 4096
    buffer_load_dwordx4 a[52:55], v4, s[24:27], s41 offen
    s_add_u32 s40, s40, 5120
    buffer_load_dwordx4 a[56:59], v4, s[24:27], s36 offen offset:1024
    buffer_load_dwordx4 a[60:63], v4, s[24:27], s37 offen offset:1024
    buffer_load_dwordx4 a[64:67], v4, s[24:27], s38 offen offset:1024
    buffer_load_dwordx4 a[68:71], v4, s[24:27], s39 offen offset:1024
    buffer_load_dwordx4 a[72:75], v4, s[24:27], s40 offen offset:0
    buffer_load_dwordx4 a[76:79], v4, s[24:27], s40 offen offset:1024
    buffer_load_dwordx4 a[80:83], v4, s[24:27], s40 offen offset:2048
    buffer_load_dwordx4 a[84:87], v4, s[24:27], s40 offen offset:3072
    s_add_u32 s41, s40, 4096
    buffer_load_dwordx4 a[88:91], v4, s[24:27], s41 offen
    s_add_u32 s40, s40, 5120
    buffer_load_dwordx4 a[92:95], v4, s[24:27], s36 offen offset:2048
    buffer_load_dwordx4 a[96:99], v4, s[24:27], s37 offen offset:2048
    buffer_load_dwordx4 a[100:103], v4, s[24:27], s38 offen offset:2048
    buffer_load_dwordx4 a[104:107], v4, s[24:27], s39 offen offset:2048
    buffer_load_dwordx4 a[108:111], v4, s[24:27], s40 offen offset:0
    buffer_load_dwordx4 a[112:115], v4, s[24:27], s40 offen offset:1024
    buffer_load_dwordx4 a[116:119], v4, s[24:27], s40 offen offset:2048
    buffer_load_dwordx4 a[120:123], v4, s[24:27], s40 offen offset:3072
    s_add_u32 s41, s40, 4096
    buffer_load_dwordx4 a[124:127], v4, s[24:27], s41 offen
    s_add_u32 s40, s40, 5120
    buffer_load_dwordx4 a[128:131], v4, s[24:27], s36 offen offset:3072
    buffer_load_dwordx4 a[132:135], v4, s[24:27], s37 offen offset:3072
    buffer_load_dwordx4 a[136:139], v4, s[24:27], s38 offen offset:3072
    buffer_load_dwordx4 a[140:143], v4, s[24:27], s39 offen offset:3072
    s_add_u32 s36, s36, 4096
    s_add_u32 s37, s37, 4096
    s_add_u32 s38, s38, 4096
    s_add_u32 s39, s39, 4096
    buffer_load_dwordx4 a[144:147], v4, s[24:27], s40 offen offset:0
    buffer_load_dwordx4 a[148:151], v4, s[24:27], s40 offen offset:1024
    buffer_load_dwordx4 a[152:155], v4, s[24:27], s40 offen offset:2048
    buffer_load_dwordx4 a[156:159], v4, s[24:27], s40 offen offset:3072
    s_add_u32 s41, s40, 4096
    buffer_load_dwordx4 a[160:163], v4, s[24:27], s41 offen
    s_add_u32 s40, s40, 5120
    buffer_load_dwordx4 a[164:167], v4, s[24:27], s36 offen offset:0
    buffer_load_dwordx4 a[168:171], v4, s[24:27], s37 offen offset:0
    buffer_load_dwordx4 a[172:175], v4, s[24:27], s38 offen offset:0
    buffer_load_dwordx4 a[176:179], v4, s[24:27], s39 offen offset:0
    buffer_load_dwordx4 a[180:183], v4, s[24:27], s40 offen offset:0
    buffer_load_dwordx4 a[184:187], v4, s[24:27], s40 offen offset:1024
    buffer_load_dwordx4 a[188:191], v4, s[24:27], s40 offen offset:2048
    buffer_load_dwordx4 a[192:195], v4, s[24:27], s40 offen offset:3072
    s_add_u32 s41, s40, 4096
    buffer_load_dwordx4 a[196:199], v4, s[24:27], s41 offen
    s_add_u32 s40, s40, 5120
    buffer_load_dwordx4 a[200:203], v4, s[24:27], s36 offen offset:1024
    buffer_load_dwordx4 a[204:207], v4, s[24:27], s37 offen offset:1024
    buffer_load_dwordx4 a[208:211], v4, s[24:27], s38 offen offset:1024
    buffer_load_dwordx4 a[212:215], v4, s[24:27], s39 offen offset:1024
    s_waitcnt vmcnt(45)
    v_mfma_f32_16x16x32_bf16 v[128:131], a[0:3], a[20:23], 0
    v_mfma_f32_16x16x32_bf16 v[148:151], a[0:3], a[24:27], 0
    v_mfma_f32_16x16x32_bf16 v[168:171], a[0:3], a[28:31], 0
    v_mfma_f32_16x16x32_bf16 v[188:191], a[0:3], a[32:35], 0
    v_mfma_f32_16x16x32_bf16 v[132:135], a[4:7], a[20:23], 0
    v_mfma_f32_16x16x32_bf16 v[152:155], a[4:7], a[24:27], 0
    v_mfma_f32_16x16x32_bf16 v[172:175], a[4:7], a[28:31], 0
    v_mfma_f32_16x16x32_bf16 v[192:195], a[4:7], a[32:35], 0
    v_mfma_f32_16x16x32_bf16 v[136:139], a[8:11], a[20:23], 0
    v_mfma_f32_16x16x32_bf16 v[156:159], a[8:11], a[24:27], 0
    v_mfma_f32_16x16x32_bf16 v[176:179], a[8:11], a[28:31], 0
    v_mfma_f32_16x16x32_bf16 v[196:199], a[8:11], a[32:35], 0
    v_mfma_f32_16x16x32_bf16 v[140:143], a[12:15], a[20:23], 0
    v_mfma_f32_16x16x32_bf16 v[160:163], a[12:15], a[24:27], 0
    v_mfma_f32_16x16x32_bf16 v[180:183], a[12:15], a[28:31], 0
    v_mfma_f32_16x16x32_bf16 v[200:203], a[12:15], a[32:35], 0
    v_mfma_f32_16x16x32_bf16 v[144:147], a[16:19], a[20:23], 0
    v_mfma_f32_16x16x32_bf16 v[164:167], a[16:19], a[24:27], 0
    v_mfma_f32_16x16x32_bf16 v[184:187], a[16:19], a[28:31], 0
    v_mfma_f32_16x16x32_bf16 v[204:207], a[16:19], a[32:35], 0
    buffer_load_dwordx4 a[0:3], v4, s[24:27], s40 offen offset:0
    buffer_load_dwordx4 a[4:7], v4, s[24:27], s40 offen offset:1024
    buffer_load_dwordx4 a[8:11], v4, s[24:27], s40 offen offset:2048
    buffer_load_dwordx4 a[12:15], v4, s[24:27], s40 offen offset:3072
    s_add_u32 s41, s40, 4096
    buffer_load_dwordx4 a[16:19], v4, s[24:27], s41 offen
    s_add_u32 s40, s40, 5120
    buffer_load_dwordx4 a[20:23], v4, s[24:27], s36 offen offset:2048
    buffer_load_dwordx4 a[24:27], v4, s[24:27], s37 offen offset:2048
    buffer_load_dwordx4 a[28:31], v4, s[24:27], s38 offen offset:2048
    buffer_load_dwordx4 a[32:35], v4, s[24:27], s39 offen offset:2048
    s_waitcnt vmcnt(45)
    v_mfma_f32_16x16x32_bf16 v[128:131], a[36:39], a[56:59], v[128:131]
    v_mfma_f32_16x16x32_bf16 v[148:151], a[36:39], a[60:63], v[148:151]
    v_mfma_f32_16x16x32_bf16 v[168:171], a[36:39], a[64:67], v[168:171]
    v_mfma_f32_16x16x32_bf16 v[188:191], a[36:39], a[68:71], v[188:191]
    v_mfma_f32_16x16x32_bf16 v[132:135], a[40:43], a[56:59], v[132:135]
    v_mfma_f32_16x16x32_bf16 v[152:155], a[40:43], a[60:63], v[152:155]
    v_mfma_f32_16x16x32_bf16 v[172:175], a[40:43], a[64:67], v[172:175]
    v_mfma_f32_16x16x32_bf16 v[192:195], a[40:43], a[68:71], v[192:195]
    v_mfma_f32_16x16x32_bf16 v[136:139], a[44:47], a[56:59], v[136:139]
    v_mfma_f32_16x16x32_bf16 v[156:159], a[44:47], a[60:63], v[156:159]
    v_mfma_f32_16x16x32_bf16 v[176:179], a[44:47], a[64:67], v[176:179]
    v_mfma_f32_16x16x32_bf16 v[196:199], a[44:47], a[68:71], v[196:199]
    v_mfma_f32_16x16x32_bf16 v[140:143], a[48:51], a[56:59], v[140:143]
    v_mfma_f32_16x16x32_bf16 v[160:163], a[48:51], a[60:63], v[160:163]
    v_mfma_f32_16x16x32_bf16 v[180:183], a[48:51], a[64:67], v[180:183]
    v_mfma_f32_16x16x32_bf16 v[200:203], a[48:51], a[68:71], v[200:203]
    v_mfma_f32_16x16x32_bf16 v[144:147], a[52:55], a[56:59], v[144:147]
    v_mfma_f32_16x16x32_bf16 v[164:167], a[52:55], a[60:63], v[164:167]
    v_mfma_f32_16x16x32_bf16 v[184:187], a[52:55], a[64:67], v[184:187]
    v_mfma_f32_16x16x32_bf16 v[204:207], a[52:55], a[68:71], v[204:207]
    buffer_load_dwordx4 a[36:39], v4, s[24:27], s40 offen offset:0
    buffer_load_dwordx4 a[40:43], v4, s[24:27], s40 offen offset:1024
    buffer_load_dwordx4 a[44:47], v4, s[24:27], s40 offen offset:2048
    buffer_load_dwordx4 a[48:51], v4, s[24:27], s40 offen offset:3072
    s_add_u32 s41, s40, 4096
    buffer_load_dwordx4 a[52:55], v4, s[24:27], s41 offen
    s_add_u32 s40, s40, 5120
    buffer_load_dwordx4 a[56:59], v4, s[24:27], s36 offen offset:3072
    buffer_load_dwordx4 a[60:63], v4, s[24:27], s37 offen offset:3072
    buffer_load_dwordx4 a[64:67], v4, s[24:27], s38 offen offset:3072
    buffer_load_dwordx4 a[68:71], v4, s[24:27], s39 offen offset:3072
    s_add_u32 s36, s36, 4096
    s_add_u32 s37, s37, 4096
    s_add_u32 s38, s38, 4096
    s_add_u32 s39, s39, 4096
    s_waitcnt vmcnt(45)
    v_mfma_f32_16x16x32_bf16 v[128:131], a[72:75], a[92:95], v[128:131]
    v_mfma_f32_16x16x32_bf16 v[148:151], a[72:75], a[96:99], v[148:151]
    v_mfma_f32_16x16x32_bf16 v[168:171], a[72:75], a[100:103], v[168:171]
    v_mfma_f32_16x16x32_bf16 v[188:191], a[72:75], a[104:107], v[188:191]
    v_mfma_f32_16x16x32_bf16 v[132:135], a[76:79], a[92:95], v[132:135]
    v_mfma_f32_16x16x32_bf16 v[152:155], a[76:79], a[96:99], v[152:155]
    v_mfma_f32_16x16x32_bf16 v[172:175], a[76:79], a[100:103], v[172:175]
    v_mfma_f32_16x16x32_bf16 v[192:195], a[76:79], a[104:107], v[192:195]
    v_mfma_f32_16x16x32_bf16 v[136:139], a[80:83], a[92:95], v[136:139]
    v_mfma_f32_16x16x32_bf16 v[156:159], a[80:83], a[96:99], v[156:159]
    v_mfma_f32_16x16x32_bf16 v[176:179], a[80:83], a[100:103], v[176:179]
    v_mfma_f32_16x16x32_bf16 v[196:199], a[80:83], a[104:107], v[196:199]
    v_mfma_f32_16x16x32_bf16 v[140:143], a[84:87], a[92:95], v[140:143]
    v_mfma_f32_16x16x32_bf16 v[160:163], a[84:87], a[96:99], v[160:163]
    v_mfma_f32_16x16x32_bf16 v[180:183], a[84:87], a[100:103], v[180:183]
    v_mfma_f32_16x16x32_bf16 v[200:203], a[84:87], a[104:107], v[200:203]
    v_mfma_f32_16x16x32_bf16 v[144:147], a[88:91], a[92:95], v[144:147]
    v_mfma_f32_16x16x32_bf16 v[164:167], a[88:91], a[96:99], v[164:167]
    v_mfma_f32_16x16x32_bf16 v[184:187], a[88:91], a[100:103], v[184:187]
    v_mfma_f32_16x16x32_bf16 v[204:207], a[88:91], a[104:107], v[204:207]
    buffer_load_dwordx4 a[72:75], v4, s[24:27], s40 offen offset:0
    buffer_load_dwordx4 a[76:79], v4, s[24:27], s40 offen offset:1024
    buffer_load_dwordx4 a[80:83], v4, s[24:27], s40 offen offset:2048
    buffer_load_dwordx4 a[84:87], v4, s[24:27], s40 offen offset:3072
    s_add_u32 s41, s40, 4096
    buffer_load_dwordx4 a[88:91], v4, s[24:27], s41 offen
    s_add_u32 s40, s40, 5120
    buffer_load_dwordx4 a[92:95], v4, s[24:27], s36 offen offset:0
    buffer_load_dwordx4 a[96:99], v4, s[24:27], s37 offen offset:0
    buffer_load_dwordx4 a[100:103], v4, s[24:27], s38 offen offset:0
    buffer_load_dwordx4 a[104:107], v4, s[24:27], s39 offen offset:0
    s_waitcnt vmcnt(45)
    v_mfma_f32_16x16x32_bf16 v[128:131], a[108:111], a[128:131], v[128:131]
    v_mfma_f32_16x16x32_bf16 v[148:151], a[108:111], a[132:135], v[148:151]
    v_mfma_f32_16x16x32_bf16 v[168:171], a[108:111], a[136:139], v[168:171]
    v_mfma_f32_16x16x32_bf16 v[188:191], a[108:111], a[140:143], v[188:191]
    v_mfma_f32_16x16x32_bf16 v[132:135], a[112:115], a[128:131], v[132:135]
    v_mfma_f32_16x16x32_bf16 v[152:155], a[112:115], a[132:135], v[152:155]
    v_mfma_f32_16x16x32_bf16 v[172:175], a[112:115], a[136:139], v[172:175]
    v_mfma_f32_16x16x32_bf16 v[192:195], a[112:115], a[140:143], v[192:195]
    v_mfma_f32_16x16x32_bf16 v[136:139], a[116:119], a[128:131], v[136:139]
    v_mfma_f32_16x16x32_bf16 v[156:159], a[116:119], a[132:135], v[156:159]
    v_mfma_f32_16x16x32_bf16 v[176:179], a[116:119], a[136:139], v[176:179]
    v_mfma_f32_16x16x32_bf16 v[196:199], a[116:119], a[140:143], v[196:199]
    v_mfma_f32_16x16x32_bf16 v[140:143], a[120:123], a[128:131], v[140:143]
    v_mfma_f32_16x16x32_bf16 v[160:163], a[120:123], a[132:135], v[160:163]
    v_mfma_f32_16x16x32_bf16 v[180:183], a[120:123], a[136:139], v[180:183]
    v_mfma_f32_16x16x32_bf16 v[200:203], a[120:123], a[140:143], v[200:203]
    v_mfma_f32_16x16x32_bf16 v[144:147], a[124:127], a[128:131], v[144:147]
    v_mfma_f32_16x16x32_bf16 v[164:167], a[124:127], a[132:135], v[164:167]
    v_mfma_f32_16x16x32_bf16 v[184:187], a[124:127], a[136:139], v[184:187]
    v_mfma_f32_16x16x32_bf16 v[204:207], a[124:127], a[140:143], v[204:207]
    buffer_load_dwordx4 a[108:111], v4, s[24:27], s40 offen offset:0
    buffer_load_dwordx4 a[112:115], v4, s[24:27], s40 offen offset:1024
    buffer_load_dwordx4 a[116:119], v4, s[24:27], s40 offen offset:2048
    buffer_load_dwordx4 a[120:123], v4, s[24:27], s40 offen offset:3072
    s_add_u32 s41, s40, 4096
    buffer_load_dwordx4 a[124:127], v4, s[24:27], s41 offen
    s_add_u32 s40, s40, 5120
    buffer_load_dwordx4 a[128:131], v4, s[24:27], s36 offen offset:1024
    buffer_load_dwordx4 a[132:135], v4, s[24:27], s37 offen offset:1024
    buffer_load_dwordx4 a[136:139], v4, s[24:27], s38 offen offset:1024
    buffer_load_dwordx4 a[140:143], v4, s[24:27], s39 offen offset:1024
    s_waitcnt vmcnt(45)
    v_mfma_f32_16x16x32_bf16 v[128:131], a[144:147], a[164:167], v[128:131]
    v_mfma_f32_16x16x32_bf16 v[148:151], a[144:147], a[168:171], v[148:151]
    v_mfma_f32_16x16x32_bf16 v[168:171], a[144:147], a[172:175], v[168:171]
    v_mfma_f32_16x16x32_bf16 v[188:191], a[144:147], a[176:179], v[188:191]
    v_mfma_f32_16x16x32_bf16 v[132:135], a[148:151], a[164:167], v[132:135]
    v_mfma_f32_16x16x32_bf16 v[152:155], a[148:151], a[168:171], v[152:155]
    v_mfma_f32_16x16x32_bf16 v[172:175], a[148:151], a[172:175], v[172:175]
    v_mfma_f32_16x16x32_bf16 v[192:195], a[148:151], a[176:179], v[192:195]
    v_mfma_f32_16x16x32_bf16 v[136:139], a[152:155], a[164:167], v[136:139]
    v_mfma_f32_16x16x32_bf16 v[156:159], a[152:155], a[168:171], v[156:159]
    v_mfma_f32_16x16x32_bf16 v[176:179], a[152:155], a[172:175], v[176:179]
    v_mfma_f32_16x16x32_bf16 v[196:199], a[152:155], a[176:179], v[196:199]
    v_mfma_f32_16x16x32_bf16 v[140:143], a[156:159], a[164:167], v[140:143]
    v_mfma_f32_16x16x32_bf16 v[160:163], a[156:159], a[168:171], v[160:163]
    v_mfma_f32_16x16x32_bf16 v[180:183], a[156:159], a[172:175], v[180:183]
    v_mfma_f32_16x16x32_bf16 v[200:203], a[156:159], a[176:179], v[200:203]
    v_mfma_f32_16x16x32_bf16 v[144:147], a[160:163], a[164:167], v[144:147]
    v_mfma_f32_16x16x32_bf16 v[164:167], a[160:163], a[168:171], v[164:167]
    v_mfma_f32_16x16x32_bf16 v[184:187], a[160:163], a[172:175], v[184:187]
    v_mfma_f32_16x16x32_bf16 v[204:207], a[160:163], a[176:179], v[204:207]
    s_waitcnt vmcnt(36)
    v_mfma_f32_16x16x32_bf16 v[128:131], a[180:183], a[200:203], v[128:131]
    v_mfma_f32_16x16x32_bf16 v[148:151], a[180:183], a[204:207], v[148:151]
    v_mfma_f32_16x16x32_bf16 v[168:171], a[180:183], a[208:211], v[168:171]
    v_mfma_f32_16x16x32_bf16 v[188:191], a[180:183], a[212:215], v[188:191]
    v_mfma_f32_16x16x32_bf16 v[132:135], a[184:187], a[200:203], v[132:135]
    v_mfma_f32_16x16x32_bf16 v[152:155], a[184:187], a[204:207], v[152:155]
    v_mfma_f32_16x16x32_bf16 v[172:175], a[184:187], a[208:211], v[172:175]
    v_mfma_f32_16x16x32_bf16 v[192:195], a[184:187], a[212:215], v[192:195]
    v_mfma_f32_16x16x32_bf16 v[136:139], a[188:191], a[200:203], v[136:139]
    v_mfma_f32_16x16x32_bf16 v[156:159], a[188:191], a[204:207], v[156:159]
    v_mfma_f32_16x16x32_bf16 v[176:179], a[188:191], a[208:211], v[176:179]
    v_mfma_f32_16x16x32_bf16 v[196:199], a[188:191], a[212:215], v[196:199]
    v_mfma_f32_16x16x32_bf16 v[140:143], a[192:195], a[200:203], v[140:143]
    v_mfma_f32_16x16x32_bf16 v[160:163], a[192:195], a[204:207], v[160:163]
    v_mfma_f32_16x16x32_bf16 v[180:183], a[192:195], a[208:211], v[180:183]
    v_mfma_f32_16x16x32_bf16 v[200:203], a[192:195], a[212:215], v[200:203]
    v_mfma_f32_16x16x32_bf16 v[144:147], a[196:199], a[200:203], v[144:147]
    v_mfma_f32_16x16x32_bf16 v[164:167], a[196:199], a[204:207], v[164:167]
    v_mfma_f32_16x16x32_bf16 v[184:187], a[196:199], a[208:211], v[184:187]
    v_mfma_f32_16x16x32_bf16 v[204:207], a[196:199], a[212:215], v[204:207]
    s_waitcnt vmcnt(27)
    v_mfma_f32_16x16x32_bf16 v[128:131], a[0:3], a[20:23], v[128:131]
    v_mfma_f32_16x16x32_bf16 v[148:151], a[0:3], a[24:27], v[148:151]
    v_mfma_f32_16x16x32_bf16 v[168:171], a[0:3], a[28:31], v[168:171]
    v_mfma_f32_16x16x32_bf16 v[188:191], a[0:3], a[32:35], v[188:191]
    v_mfma_f32_16x16x32_bf16 v[132:135], a[4:7], a[20:23], v[132:135]
    v_mfma_f32_16x16x32_bf16 v[152:155], a[4:7], a[24:27], v[152:155]
    v_mfma_f32_16x16x32_bf16 v[172:175], a[4:7], a[28:31], v[172:175]
    v_mfma_f32_16x16x32_bf16 v[192:195], a[4:7], a[32:35], v[192:195]
    v_mfma_f32_16x16x32_bf16 v[136:139], a[8:11], a[20:23], v[136:139]
    v_mfma_f32_16x16x32_bf16 v[156:159], a[8:11], a[24:27], v[156:159]
    v_mfma_f32_16x16x32_bf16 v[176:179], a[8:11], a[28:31], v[176:179]
    v_mfma_f32_16x16x32_bf16 v[196:199], a[8:11], a[32:35], v[196:199]
    v_mfma_f32_16x16x32_bf16 v[140:143], a[12:15], a[20:23], v[140:143]
    v_mfma_f32_16x16x32_bf16 v[160:163], a[12:15], a[24:27], v[160:163]
    v_mfma_f32_16x16x32_bf16 v[180:183], a[12:15], a[28:31], v[180:183]
    v_mfma_f32_16x16x32_bf16 v[200:203], a[12:15], a[32:35], v[200:203]
    v_mfma_f32_16x16x32_bf16 v[144:147], a[16:19], a[20:23], v[144:147]
    v_mfma_f32_16x16x32_bf16 v[164:167], a[16:19], a[24:27], v[164:167]
    v_mfma_f32_16x16x32_bf16 v[184:187], a[16:19], a[28:31], v[184:187]
    v_mfma_f32_16x16x32_bf16 v[204:207], a[16:19], a[32:35], v[204:207]
    s_waitcnt vmcnt(18)
    v_mfma_f32_16x16x32_bf16 v[128:131], a[36:39], a[56:59], v[128:131]
    v_mfma_f32_16x16x32_bf16 v[148:151], a[36:39], a[60:63], v[148:151]
    v_mfma_f32_16x16x32_bf16 v[168:171], a[36:39], a[64:67], v[168:171]
    v_mfma_f32_16x16x32_bf16 v[188:191], a[36:39], a[68:71], v[188:191]
    v_mfma_f32_16x16x32_bf16 v[132:135], a[40:43], a[56:59], v[132:135]
    v_mfma_f32_16x16x32_bf16 v[152:155], a[40:43], a[60:63], v[152:155]
    v_mfma_f32_16x16x32_bf16 v[172:175], a[40:43], a[64:67], v[172:175]
    v_mfma_f32_16x16x32_bf16 v[192:195], a[40:43], a[68:71], v[192:195]
    v_mfma_f32_16x16x32_bf16 v[136:139], a[44:47], a[56:59], v[136:139]
    v_mfma_f32_16x16x32_bf16 v[156:159], a[44:47], a[60:63], v[156:159]
    v_mfma_f32_16x16x32_bf16 v[176:179], a[44:47], a[64:67], v[176:179]
    v_mfma_f32_16x16x32_bf16 v[196:199], a[44:47], a[68:71], v[196:199]
    v_mfma_f32_16x16x32_bf16 v[140:143], a[48:51], a[56:59], v[140:143]
    v_mfma_f32_16x16x32_bf16 v[160:163], a[48:51], a[60:63], v[160:163]
    v_mfma_f32_16x16x32_bf16 v[180:183], a[48:51], a[64:67], v[180:183]
    v_mfma_f32_16x16x32_bf16 v[200:203], a[48:51], a[68:71], v[200:203]
    v_mfma_f32_16x16x32_bf16 v[144:147], a[52:55], a[56:59], v[144:147]
    v_mfma_f32_16x16x32_bf16 v[164:167], a[52:55], a[60:63], v[164:167]
    v_mfma_f32_16x16x32_bf16 v[184:187], a[52:55], a[64:67], v[184:187]
    v_mfma_f32_16x16x32_bf16 v[204:207], a[52:55], a[68:71], v[204:207]
    s_waitcnt vmcnt(9)
    v_mfma_f32_16x16x32_bf16 v[128:131], a[72:75], a[92:95], v[128:131]
    v_mfma_f32_16x16x32_bf16 v[148:151], a[72:75], a[96:99], v[148:151]
    v_mfma_f32_16x16x32_bf16 v[168:171], a[72:75], a[100:103], v[168:171]
    v_mfma_f32_16x16x32_bf16 v[188:191], a[72:75], a[104:107], v[188:191]
    v_mfma_f32_16x16x32_bf16 v[132:135], a[76:79], a[92:95], v[132:135]
    v_mfma_f32_16x16x32_bf16 v[152:155], a[76:79], a[96:99], v[152:155]
    v_mfma_f32_16x16x32_bf16 v[172:175], a[76:79], a[100:103], v[172:175]
    v_mfma_f32_16x16x32_bf16 v[192:195], a[76:79], a[104:107], v[192:195]
    v_mfma_f32_16x16x32_bf16 v[136:139], a[80:83], a[92:95], v[136:139]
    v_mfma_f32_16x16x32_bf16 v[156:159], a[80:83], a[96:99], v[156:159]
    v_mfma_f32_16x16x32_bf16 v[176:179], a[80:83], a[100:103], v[176:179]
    v_mfma_f32_16x16x32_bf16 v[196:199], a[80:83], a[104:107], v[196:199]
    v_mfma_f32_16x16x32_bf16 v[140:143], a[84:87], a[92:95], v[140:143]
    v_mfma_f32_16x16x32_bf16 v[160:163], a[84:87], a[96:99], v[160:163]
    v_mfma_f32_16x16x32_bf16 v[180:183], a[84:87], a[100:103], v[180:183]
    v_mfma_f32_16x16x32_bf16 v[200:203], a[84:87], a[104:107], v[200:203]
    v_mfma_f32_16x16x32_bf16 v[144:147], a[88:91], a[92:95], v[144:147]
    v_mfma_f32_16x16x32_bf16 v[164:167], a[88:91], a[96:99], v[164:167]
    v_mfma_f32_16x16x32_bf16 v[184:187], a[88:91], a[100:103], v[184:187]
    v_mfma_f32_16x16x32_bf16 v[204:207], a[88:91], a[104:107], v[204:207]
    s_waitcnt vmcnt(0)
    v_mfma_f32_16x16x32_bf16 v[128:131], a[108:111], a[128:131], v[128:131]
    v_mfma_f32_16x16x32_bf16 v[148:151], a[108:111], a[132:135], v[148:151]
    v_mfma_f32_16x16x32_bf16 v[168:171], a[108:111], a[136:139], v[168:171]
    v_mfma_f32_16x16x32_bf16 v[188:191], a[108:111], a[140:143], v[188:191]
    v_mfma_f32_16x16x32_bf16 v[132:135], a[112:115], a[128:131], v[132:135]
    v_mfma_f32_16x16x32_bf16 v[152:155], a[112:115], a[132:135], v[152:155]
    v_mfma_f32_16x16x32_bf16 v[172:175], a[112:115], a[136:139], v[172:175]
    v_mfma_f32_16x16x32_bf16 v[192:195], a[112:115], a[140:143], v[192:195]
    v_mfma_f32_16x16x32_bf16 v[136:139], a[116:119], a[128:131], v[136:139]
    v_mfma_f32_16x16x32_bf16 v[156:159], a[116:119], a[132:135], v[156:159]
    v_mfma_f32_16x16x32_bf16 v[176:179], a[116:119], a[136:139], v[176:179]
    v_mfma_f32_16x16x32_bf16 v[196:199], a[116:119], a[140:143], v[196:199]
    v_mfma_f32_16x16x32_bf16 v[140:143], a[120:123], a[128:131], v[140:143]
    v_mfma_f32_16x16x32_bf16 v[160:163], a[120:123], a[132:135], v[160:163]
    v_mfma_f32_16x16x32_bf16 v[180:183], a[120:123], a[136:139], v[180:183]
    v_mfma_f32_16x16x32_bf16 v[200:203], a[120:123], a[140:143], v[200:203]
    v_mfma_f32_16x16x32_bf16 v[144:147], a[124:127], a[128:131], v[144:147]
    v_mfma_f32_16x16x32_bf16 v[164:167], a[124:127], a[132:135], v[164:167]
    v_mfma_f32_16x16x32_bf16 v[184:187], a[124:127], a[136:139], v[184:187]
    v_mfma_f32_16x16x32_bf16 v[204:207], a[124:127], a[140:143], v[204:207]
    s_nop 9
    s_mul_i32 s45, s17, 5120
    v_add_u32 v7, s45, v4
    v_add_u32 v13, 40960, v7
    ds_write_b128 v7, v[128:131] offset:0
    ds_write_b128 v7, v[132:135] offset:1024
    ds_write_b128 v7, v[136:139] offset:2048
    ds_write_b128 v7, v[140:143] offset:3072
    ds_write_b128 v7, v[144:147] offset:4096
    ds_write_b128 v7, v[148:151] offset:20480
    ds_write_b128 v7, v[152:155] offset:21504
    ds_write_b128 v7, v[156:159] offset:22528
    ds_write_b128 v7, v[160:163] offset:23552
    ds_write_b128 v7, v[164:167] offset:24576
    ds_write_b128 v13, v[168:171] offset:0
    ds_write_b128 v13, v[172:175] offset:1024
    ds_write_b128 v13, v[176:179] offset:2048
    ds_write_b128 v13, v[180:183] offset:3072
    ds_write_b128 v13, v[184:187] offset:4096
    ds_write_b128 v13, v[188:191] offset:20480
    ds_write_b128 v13, v[192:195] offset:21504
    ds_write_b128 v13, v[196:199] offset:22528
    ds_write_b128 v13, v[200:203] offset:23552
    ds_write_b128 v13, v[204:207] offset:24576
    s_waitcnt lgkmcnt(0)
    s_barrier
    s_mul_i32 s45, s17, 20480
    v_add_u32 v7, s45, v4
    ds_read_b128 v[32:35], v7 offset:0
    ds_read_b128 v[36:39], v7 offset:1024
    ds_read_b128 v[40:43], v7 offset:2048
    ds_read_b128 v[44:47], v7 offset:3072
    ds_read_b128 v[48:51], v7 offset:4096
    ds_read_b128 v[52:55], v7 offset:5120
    ds_read_b128 v[56:59], v7 offset:6144
    ds_read_b128 v[60:63], v7 offset:7168
    ds_read_b128 v[64:67], v7 offset:8192
    ds_read_b128 v[68:71], v7 offset:9216
    ds_read_b128 v[72:75], v7 offset:10240
    ds_read_b128 v[76:79], v7 offset:11264
    ds_read_b128 v[80:83], v7 offset:12288
    ds_read_b128 v[84:87], v7 offset:13312
    ds_read_b128 v[88:91], v7 offset:14336
    ds_read_b128 v[92:95], v7 offset:15360
    ds_read_b128 v[96:99], v7 offset:16384
    ds_read_b128 v[100:103], v7 offset:17408
    ds_read_b128 v[104:107], v7 offset:18432
    ds_read_b128 v[108:111], v7 offset:19456
    s_waitcnt lgkmcnt(0)
    v_add_f32 v32, v32, v52
    v_add_f32 v72, v72, v92
    v_add_f32 v33, v33, v53
    v_add_f32 v73, v73, v93
    v_add_f32 v34, v34, v54
    v_add_f32 v74, v74, v94
    v_add_f32 v35, v35, v55
    v_add_f32 v75, v75, v95
    v_add_f32 v36, v36, v56
    v_add_f32 v76, v76, v96
    v_add_f32 v37, v37, v57
    v_add_f32 v77, v77, v97
    v_add_f32 v38, v38, v58
    v_add_f32 v78, v78, v98
    v_add_f32 v39, v39, v59
    v_add_f32 v79, v79, v99
    v_add_f32 v40, v40, v60
    v_add_f32 v80, v80, v100
    v_add_f32 v41, v41, v61
    v_add_f32 v81, v81, v101
    v_add_f32 v42, v42, v62
    v_add_f32 v82, v82, v102
    v_add_f32 v43, v43, v63
    v_add_f32 v83, v83, v103
    v_add_f32 v44, v44, v64
    v_add_f32 v84, v84, v104
    v_add_f32 v45, v45, v65
    v_add_f32 v85, v85, v105
    v_add_f32 v46, v46, v66
    v_add_f32 v86, v86, v106
    v_add_f32 v47, v47, v67
    v_add_f32 v87, v87, v107
    v_add_f32 v48, v48, v68
    v_add_f32 v88, v88, v108
    v_add_f32 v49, v49, v69
    v_add_f32 v89, v89, v109
    v_add_f32 v50, v50, v70
    v_add_f32 v90, v90, v110
    v_add_f32 v51, v51, v71
    v_add_f32 v91, v91, v111
    v_add_f32 v32, v32, v72
    v_add_f32 v33, v33, v73
    v_add_f32 v34, v34, v74
    v_add_f32 v35, v35, v75
    v_add_f32 v36, v36, v76
    v_add_f32 v37, v37, v77
    v_add_f32 v38, v38, v78
    v_add_f32 v39, v39, v79
    v_add_f32 v40, v40, v80
    v_add_f32 v41, v41, v81
    v_add_f32 v42, v42, v82
    v_add_f32 v43, v43, v83
    v_add_f32 v44, v44, v84
    v_add_f32 v45, v45, v85
    v_add_f32 v46, v46, v86
    v_add_f32 v47, v47, v87
    v_add_f32 v48, v48, v88
    v_add_f32 v49, v49, v89
    v_add_f32 v50, v50, v90
    v_add_f32 v51, v51, v91
    v_cvt_pk_bf16_f32 v112, v32, v33
    v_cvt_pk_bf16_f32 v113, v34, v35
    v_cvt_pk_bf16_f32 v114, v36, v37
    v_cvt_pk_bf16_f32 v115, v38, v39
    v_cvt_pk_bf16_f32 v116, v40, v41
    v_cvt_pk_bf16_f32 v117, v42, v43
    v_cvt_pk_bf16_f32 v118, v44, v45
    v_cvt_pk_bf16_f32 v119, v46, v47
    v_cvt_pk_bf16_f32 v120, v48, v49
    v_cvt_pk_bf16_f32 v121, v50, v51
    s_lshl_b32 s32, s15, 6
    s_lshl_b32 s33, s17, 4
    s_add_u32 s32, s32, s33
    v_add_u32 v4, s32, v2
    v_mul_u32_u24 v4, 1280, v4
    v_lshl_add_u32 v4, v3, 3, v4
    s_mul_i32 s35, s16, 160
    v_add_u32 v4, s35, v4
    buffer_store_dwordx2 v[112:113], v4, s[28:31], 0 offen offset:0
    buffer_store_dwordx2 v[114:115], v4, s[28:31], 0 offen offset:32
    buffer_store_dwordx2 v[116:117], v4, s[28:31], 0 offen offset:64
    buffer_store_dwordx2 v[118:119], v4, s[28:31], 0 offen offset:96
    buffer_store_dwordx2 v[120:121], v4, s[28:31], 0 offen offset:128
k3_kernel_fin:
k3_kernel_done:
    s_endpgm
.section .rodata,"a"
.p2align 6
.amdhsa_kernel k1_kernel
  .amdhsa_next_free_vgpr 128
  .amdhsa_next_free_sgpr 102
  .amdhsa_accum_offset 128
  .amdhsa_group_segment_fixed_size 0
  .amdhsa_kernarg_size 80
  .amdhsa_user_sgpr_count 2
  .amdhsa_user_sgpr_kernarg_segment_ptr 1
  .amdhsa_system_sgpr_workgroup_id_x 1
.end_amdhsa_kernel
.p2align 6
.amdhsa_kernel k2_kernel
  .amdhsa_next_free_vgpr 256
  .amdhsa_next_free_sgpr 102
  .amdhsa_accum_offset 256
  .amdhsa_group_segment_fixed_size 0
  .amdhsa_kernarg_size 80
  .amdhsa_user_sgpr_count 2
  .amdhsa_user_sgpr_kernarg_segment_ptr 1
  .amdhsa_system_sgpr_workgroup_id_x 1
.end_amdhsa_kernel
.p2align 6
.amdhsa_kernel k3_kernel
  .amdhsa_next_free_vgpr 472
  .amdhsa_next_free_sgpr 102
  .amdhsa_accum_offset 256
  .amdhsa_group_segment_fixed_size 0
  .amdhsa_kernarg_size 80
  .amdhsa_user_sgpr_count 2
  .amdhsa_user_sgpr_kernarg_segment_ptr 1
  .amdhsa_system_sgpr_workgroup_id_x 1
.end_amdhsa_kernel
```
